```python
import torch

def _softmax(x, axis=-1):
    return torch.softmax(x, dim=axis)
def _gelu(x):
    return torch.nn.functional.gelu(x, approximate="tanh")
def _silu(x):
    return torch.nn.functional.silu(x)
def _sigmoid(x):
    return torch.sigmoid(x)
def _layernorm(x, axis=-1, eps=1e-5):
    m = x.mean(dim=axis, keepdim=True)
    v = x.var(dim=axis, keepdim=True, unbiased=False)
    return (x - m) / torch.sqrt(v + eps)
def _scatter_add(tgt, idx, src, axis=0):
    return tgt.clone().index_add_(axis, idx, src)
def _segment_sum(src, seg, n):
    out = torch.zeros((n,) + src.shape[1:], dtype=src.dtype)
    return out.index_add_(0, seg, src)
def _pad(x, pw):
    flat = tuple(v for pair in reversed(pw) for v in pair)
    return torch.nn.functional.pad(x, flat)

kernel_name = 'parallel_sum__sliding_local_dilated__mixer_s_mlp__prompt'

def setup_inputs():

    _w = (lambda a: (lambda t: t.to(torch.bfloat16) if t.is_floating_point() else t)(torch.as_tensor(a)))
    def _A_setup():
        B, S, D = 1, 2048, 512
        return {
            "x": _w((lambda *s: torch.randn(*s, dtype=torch.bfloat16) * 0.05)(B, S, D)),
            "wqkv": _w((lambda *s: torch.randn(*s, dtype=torch.bfloat16) * 0.05)(D, 3 * D)),
            "wo": _w((lambda *s: torch.randn(*s, dtype=torch.bfloat16) * 0.05)(D, D)),
        }
    _A_in = _A_setup()

    def _B_setup():
        B, S, D, F = 1, 2048, 512, 1792
        return {
            "x":  _w((lambda *s: torch.randn(*s, dtype=torch.bfloat16) * 0.05)(B, S, D)),
            "w1": _w((lambda *s: torch.randn(*s, dtype=torch.bfloat16) * 0.8)(D, D) * (D ** -0.5)),
            "w2": _w((lambda *s: torch.randn(*s, dtype=torch.bfloat16) * 0.8)(D, D) * (D ** -0.5)),
            "w3": _w((lambda *s: torch.randn(*s, dtype=torch.bfloat16) * 0.8)(D, F) * (D ** -0.5)),
            "w4": _w((lambda *s: torch.randn(*s, dtype=torch.bfloat16) * 0.8)(F, D) * (F ** -0.5)),
        }
    _B_in = _B_setup()

    return {
        "A_x": _A_in["x"],
        "A_wqkv": _A_in["wqkv"],
        "A_wo": _A_in["wo"],
        "B_x": _B_in["x"],
        "B_w1": _B_in["w1"],
        "B_w2": _B_in["w2"],
        "B_w3": _B_in["w3"],
        "B_w4": _B_in["w4"],
    }

def reference(A_x, A_wqkv, A_wo, B_x, B_w1, B_w2, B_w3, B_w4):
    def _A_ref(x, wqkv, wo):
        B, S, D = x.shape
        H = 32; Dh = D // H
        W, dil = 8, 2
        qkv = (lambda x, *d: x.permute(*d))((x @ wqkv).reshape(B, S, 3, H, Dh), 2, 0, 3, 1, 4)
        q, k, v = qkv[0], qkv[1], qkv[2]
        scale = Dh ** -0.5
        pos = torch.arange(S)
        off = torch.arange(W) * dil
        idx = pos[:, None] - off[None, :]
        mask = idx >= 0
        idx_c = torch.where(mask, idx, 0).reshape(-1)
        kg = k[:, :, idx_c, :].reshape(B, H, S, W, Dh)
        vg = v[:, :, idx_c, :].reshape(B, H, S, W, Dh)
        logits = torch.einsum("bhsd,bhswd->bhsw", q, kg) * scale
        logits = torch.where(mask[None, None, :, :], logits, -1e9)
        attn = _softmax(logits, axis=-1)
        o = torch.einsum("bhsw,bhswd->bhsd", attn, vg)
        return (lambda x, *d: x.permute(*d))(o, 0, 2, 1, 3).reshape(B, S, D) @ wo

    def _B_ref(x, w1, w2, w3, w4):
        B, S, D = x.shape
        h = _gelu(_layernorm(x, axis=-1) @ w1)
        c = D // 4
        g0 = _pad(h[:, :, 0*c:1*c], ((0, 0), (1, 0), (0, 0)))[:, :S, :]
        g1 = _pad(h[:, :, 1*c:2*c], ((0, 0), (0, 1), (0, 0)))[:, 1:, :]
        g2 = _pad(h[:, :, 2*c:3*c], ((0, 0), (2, 0), (0, 0)))[:, :S, :]
        g3 = _pad(h[:, :, 3*c:   ], ((0, 0), (0, 2), (0, 0)))[:, 2:, :]
        hs = torch.concatenate([g0, g1, g2, g3], axis=-1) @ w2
        x1 = x + hs
        h2 = _gelu(_layernorm(x1, axis=-1) @ w3) @ w4
        return x1 + h2

    x = A_x
    xn = _layernorm(x, axis=-1)
    return x + _A_ref(xn, A_wqkv, A_wo) + _B_ref(xn, B_w1, B_w2, B_w3, B_w4)
```

```asm
; @launch grid=(256,1,1) block=(512,1,1) lds=163840
.amdgcn_target "amdgcn-amd-amdhsa--gfx950"
.text
.globl parallel_sum__sliding_local_dilated__mixer_s_mlp__prompt_kernel
.p2align 8
.type parallel_sum__sliding_local_dilated__mixer_s_mlp__prompt_kernel,@function
parallel_sum__sliding_local_dilated__mixer_s_mlp__prompt_kernel:
    s_load_dwordx2 s[4:5], s[0:1], 0
    s_load_dwordx2 s[16:17], s[0:1], 32
    s_getpc_b64 s[54:55]
    v_lshlrev_b32 v5, 4, v0
    v_lshrrev_b32_e64 v6, 6, v0
    s_cmp_ge_u32 s2, 256
    s_cbranch_scc1 L_END
    global_load_dword v9, v5, s[54:55]
    v_readfirstlane_b32 s43, v6
    s_lshr_b32 s51, s2, 3
    s_and_b32 s46, s2, 7
    s_lshr_b32 s45, s51, 3
    s_lshl2_add_u32 s3, s46, s45
    s_and_b32 s40, s51, 7
    s_lshl_b32 s53, s45, 8
    s_cmp_eq_u32 s40, 3
    s_cselect_b32 s53, s53, 0
    s_add_u32 s45, s45, s51
    s_and_b32 s45, s45, 3
    s_lshl_b32 s78, s45, 8
    v_and_b32 v2, 15, v0
    v_bfe_u32 v3, v0, 4, 2
    s_cmp_ge_u32 s43, 4
    s_cbranch_scc1 L_COMPUTE
    s_mov_b32 s7, 0x20000
    v_bfe_u32 v23, v0, 3, 3
    v_lshlrev_b32_e64 v5, 2, v3
    v_bitop3_b32 v5, v5, v0, 7 bitop3:0x28
    v_lshlrev_b32 v22, 4, v5
    s_lshl_b32 s50, s43, 12
    s_lshl_b32 s46, s40, 7
    s_lshl3_add_u32 s45, s50, s46
    v_lshl_add_u32 v5, v23, 10, v22
    v_add_u32 v16, s45, v5
    v_xor_b32 v6, 32, v16
    v_add_u32 v20, 7168, v6
    v_add_u32 v18, 14336, v16
    v_add_u32 v21, 21504, v6
    s_mov_b32 s19, s7
    s_lshl_b32 s18, s7, 2
    s_waitcnt lgkmcnt(0)
    s_lshl_b32 s49, s78, 9
    s_add_u32 m0, s50, 98304
    s_nop 0
    s_nop 0
    buffer_load_dwordx4 v16, s[16:19], s49 offen offset:0 lds
    buffer_load_dwordx4 v20, s[16:19], s49 offen offset:1024 lds
    buffer_load_dwordx4 v18, s[16:19], s49 offen offset:2048 lds
    buffer_load_dwordx4 v21, s[16:19], s49 offen offset:3072 lds
    s_mul_i32 s47, s43, 20
    s_lshl_b32 s48, s3, 6
    s_sub_u32 s48, s48, 14
    v_add_u32 v7, s47, v3
    v_lshlrev_b32_e64 v6, 1, v7
    v_bitop3_b32 v6, v6, v2, 15 bitop3:0x28
    v_add_lshl_u32 v7, s48, v7, 10
    v_lshl_add_u32 v10, v6, 4, v7
    s_xor_b32 s74, s78, s53
    s_mulk_i32 s74, 81
    s_lshl_b32 s52, s47, 8
    s_addk_i32 s52, 7168
    s_lshl_b32 s6, s7, 4
    s_nop 0
    v_xor_b32 v6, 0x80, v10
    v_add_u32 v11, 4096, v6
    v_add_u32 v12, 8192, v10
    v_add_u32 v13, 12288, v6
    v_add_u32 v14, 16384, v10
    s_add_u32 m0, s74, s52
    s_nop 0
    buffer_load_dwordx4 v10, s[4:7], s78 offen lds
    s_addk_i32 m0, 0x400
    s_nop 0
    buffer_load_dwordx4 v11, s[4:7], s78 offen lds
    s_addk_i32 m0, 0x400
    s_nop 0
    buffer_load_dwordx4 v12, s[4:7], s78 offen lds
    s_addk_i32 m0, 0x400
    s_nop 0
    buffer_load_dwordx4 v13, s[4:7], s78 offen lds
    s_addk_i32 m0, 0x400
    s_nop 0
    buffer_load_dwordx4 v14, s[4:7], s78 offen lds
    s_load_dwordx2 s[8:9], s[0:1], 8
    s_load_dwordx2 s[12:13], s[0:1], 16
    s_load_dwordx2 s[20:21], s[0:1], 40
    s_load_dwordx2 s[24:25], s[0:1], 48
    s_load_dwordx2 s[28:29], s[0:1], 56
    s_load_dwordx2 s[32:33], s[0:1], 72
    s_load_dwordx2 s[36:37], s[0:1], 80
    s_lshl2_add_u32 s45, s51, s43
    s_lshl_b32 s45, s45, 8
    s_addk_i32 s45, 0x2000
    v_and_b32 v5, 1, v0
    v_lshl_add_u32 v5, v5, 7, s45
    v_min_u32 v5, L_CODE_END-parallel_sum__sliding_local_dilated__mixer_s_mlp__prompt_kernel-256, v5
    global_load_dword v9, v5, s[54:55]
    s_add_u32 s79, s78, 256
    s_and_b32 s79, s79, 0x300
    s_xor_b32 s75, s79, s53
    s_mulk_i32 s75, 81
    s_add_u32 s80, s78, 512
    s_and_b32 s80, s80, 0x300
    s_xor_b32 s76, s80, s53
    s_mulk_i32 s76, 81
    s_add_u32 s81, s78, 768
    s_and_b32 s81, s81, 0x300
    s_xor_b32 s77, s81, s53
    s_mulk_i32 s77, 81
    v_and_b32 v1, 63, v0
    v_lshlrev_b32_e64 v4, 4, v1
    s_lshr_b32 s41, s3, 1
    s_and_b32 s42, s51, 15
    s_waitcnt lgkmcnt(0)
    s_mov_b32 s10, 1572864
    s_mov_b32 s11, s7
    s_mov_b32 s14, 524288
    s_mov_b32 s15, s7
    s_mov_b32 s22, 524288
    s_mov_b32 s23, s7
    s_mov_b32 s26, 1835008
    s_mov_b32 s27, s7
    s_mov_b32 s30, 1835008
    s_mov_b32 s31, s7
    s_mov_b32 s34, 256
    s_mov_b32 s35, s7
    s_mov_b32 s38, 15728640
    s_mov_b32 s39, s7
    s_lshl2_add_u32 s45, s2, s43
    s_mul_i32 s46, s45, 1536
    v_min_u32_e64 v5, 11, v1
    v_lshl_add_u32 v25, v5, 7, s46
    s_mul_i32 s46, s45, 1792
    v_min_u32_e64 v5, 13, v1
    v_lshl_add_u32 v26, v5, 7, s46
    s_mul_i32 s46, s45, 512
    v_min_u32_e64 v5, 3, v1
    v_lshl_add_u32 v27, v5, 7, s46
    buffer_load_dword v9, v25, s[8:11], 0 offen
    v_mov_b64 v[32:33], 0
    v_mov_b64 v[34:35], 0
    s_lshl2_add_u32 s45, s41, s43
    s_lshl_b32 s45, s45, 9
    s_add_u32 s45, s45, 14155776
    s_cmp_eq_u32 s42, 0
    s_cselect_b32 s82, 0, 1073741824
    v_lshl_add_u32 v5, v1, 3, s82
    buffer_store_dwordx2 v[32:33], v5, s[36:39], s45 offen sc1
    buffer_load_dword v9, v32, s[32:35], 0 offen sc1
    v_min_u32 v28, 1, v1
    v_lshlrev_b32 v28, 30, v28
    v_mov_b32 v29, 1
    s_getreg_b32 s45, hwreg(HW_REG_XCC_ID)
    s_and_b32 s45, s45, 7
    s_and_b32 s46, s2, 7
    s_lshl3_add_u32 s45, s45, s46
    s_add_u32 s45, s45, 1
    s_mul_i32 s45, s45, 0x01010101
    v_mov_b32_e64 v30, s45
    v_mov_b32 v36, 0x3f803f80
    s_lshl_b32 s45, s43, 3
    v_add_u32 v5, s45, v23
    v_mul_u32_u24 v5, 3072, v5
    s_lshl_b32 s46, s40, 7
    v_add3_u32 v31, v5, s46, v22
    s_lshl_b32 s45, s43, 5
    s_and_b32 s45, s45, 32
    v_xor_b32 v31, s45, v31
    s_mul_i32 s83, s43, 3072
    s_add_u32 m0, s75, s52
    s_nop 0
    buffer_load_dwordx4 v10, s[4:7], s79 offen lds
    s_addk_i32 m0, 0x400
    s_nop 0
    buffer_load_dwordx4 v11, s[4:7], s79 offen lds
    s_addk_i32 m0, 0x400
    s_nop 0
    buffer_load_dwordx4 v12, s[4:7], s79 offen lds
    s_addk_i32 m0, 0x400
    s_nop 0
    buffer_load_dwordx4 v13, s[4:7], s79 offen lds
    s_addk_i32 m0, 0x400
    s_nop 0
    buffer_load_dwordx4 v14, s[4:7], s79 offen lds
    s_lshl_b32 s49, s79, 9
    s_add_u32 m0, s50, 114688
    s_nop 0
    buffer_load_dwordx4 v16, s[16:19], s49 offen offset:0 lds
    buffer_load_dwordx4 v20, s[16:19], s49 offen offset:1024 lds
    buffer_load_dwordx4 v18, s[16:19], s49 offen offset:2048 lds
    buffer_load_dwordx4 v21, s[16:19], s49 offen offset:3072 lds
    s_add_u32 m0, s76, s52
    s_nop 0
    buffer_load_dwordx4 v10, s[4:7], s80 offen lds
    s_waitcnt vmcnt(14)
    s_barrier
    s_addk_i32 m0, 0x400
    s_nop 0
    buffer_load_dwordx4 v11, s[4:7], s80 offen lds
    s_addk_i32 m0, 0x400
    s_nop 0
    buffer_load_dwordx4 v12, s[4:7], s80 offen lds
    s_addk_i32 m0, 0x400
    s_nop 0
    buffer_load_dwordx4 v13, s[4:7], s80 offen lds
    s_addk_i32 m0, 0x400
    s_nop 0
    buffer_load_dwordx4 v14, s[4:7], s80 offen lds
    s_add_u32 m0, s77, s52
    s_nop 0
    buffer_load_dwordx4 v10, s[4:7], s81 offen lds
    s_addk_i32 m0, 0x400
    s_nop 0
    buffer_load_dwordx4 v11, s[4:7], s81 offen lds
    s_addk_i32 m0, 0x400
    s_nop 0
    buffer_load_dwordx4 v12, s[4:7], s81 offen lds
    s_addk_i32 m0, 0x400
    s_nop 0
    buffer_load_dwordx4 v13, s[4:7], s81 offen lds
    s_addk_i32 m0, 0x400
    s_nop 0
    buffer_load_dwordx4 v14, s[4:7], s81 offen lds
    s_waitcnt vmcnt(10)
    s_barrier
    s_lshl_b32 s49, s80, 9
    s_add_u32 m0, s50, 131072
    s_nop 0
    buffer_load_dwordx4 v16, s[16:19], s49 offen offset:0 lds
    buffer_load_dwordx4 v20, s[16:19], s49 offen offset:1024 lds
    buffer_load_dwordx4 v18, s[16:19], s49 offen offset:2048 lds
    buffer_load_dwordx4 v21, s[16:19], s49 offen offset:3072 lds
    s_lshl_b32 s49, s81, 9
    s_add_u32 m0, s50, 147456
    s_nop 0
    buffer_load_dwordx4 v16, s[16:19], s49 offen offset:0 lds
    buffer_store_byte v30, v28, s[32:35], s51 offen
    s_waitcnt vmcnt(11)
    s_barrier
    buffer_load_dwordx4 v20, s[16:19], s49 offen offset:1024 lds
    buffer_load_dwordx4 v18, s[16:19], s49 offen offset:2048 lds
    buffer_load_dwordx4 v21, s[16:19], s49 offen offset:3072 lds
    s_xor_b32 s49, s53, 0
    s_add_u32 m0, s83, 90112
    s_mulk_i32 s49, 1536
    buffer_load_dwordx4 v31, s[8:11], s49 offen offset:0 lds
    buffer_load_dwordx4 v31, s[8:11], s49 offen offset:1024 lds
    buffer_load_dwordx4 v31, s[8:11], s49 offen offset:2048 lds
    s_xor_b32 s49, s53, 64
    s_add_u32 m0, s83, 102400
    s_mulk_i32 s49, 1536
    buffer_load_dwordx4 v31, s[8:11], s49 offen offset:0 lds
    buffer_load_dwordx4 v31, s[8:11], s49 offen offset:1024 lds
    buffer_load_dwordx4 v31, s[8:11], s49 offen offset:2048 lds
    s_waitcnt vmcnt(11)
    s_barrier
    buffer_load_dword v9, v27, s[20:23], 0 offen
    buffer_load_dword v9, v26, s[24:27], 0 offen
    buffer_load_dword v9, v27, s[12:15], 0 offen
    buffer_load_dword v9, v26, s[28:31], 0 offen
    s_waitcnt vmcnt(10)
    s_barrier
    s_xor_b32 s49, s53, 128
    s_add_u32 m0, s83, 114688
    s_mulk_i32 s49, 1536
    s_nop 0
    buffer_load_dwordx4 v31, s[8:11], s49 offen offset:0 lds
    buffer_load_dwordx4 v31, s[8:11], s49 offen offset:1024 lds
    buffer_load_dwordx4 v31, s[8:11], s49 offen offset:2048 lds
    s_xor_b32 s49, s53, 192
    s_add_u32 m0, s83, 126976
    s_mulk_i32 s49, 1536
    buffer_load_dwordx4 v31, s[8:11], s49 offen offset:0 lds
    buffer_load_dwordx4 v31, s[8:11], s49 offen offset:1024 lds
    buffer_load_dwordx4 v31, s[8:11], s49 offen offset:2048 lds
    s_waitcnt vmcnt(10)
    s_barrier
    s_xor_b32 s49, s53, 256
    s_add_u32 m0, s83, 139264
    s_mulk_i32 s49, 1536
    buffer_load_dwordx4 v31, s[8:11], s49 offen offset:0 lds
    buffer_load_dwordx4 v31, s[8:11], s49 offen offset:1024 lds
    buffer_load_dwordx4 v31, s[8:11], s49 offen offset:2048 lds
    s_cmp_eq_u32 s43, 0
    s_cselect_b32 s47, s82, 1073741824
    v_or_b32 v8, s47, v28
    s_lshl_b32 s45, s41, 2
    buffer_store_dword v29, v8, s[32:35], s45 offen offset:128 sc1
    s_mov_b32 s101, 200000
    v_lshlrev_b32 v46, 2, v2
    v_min_u32_e64 v47, 24, v46
    s_lshl_b32 s47, s41, 11
    s_add_u32 s47, s47, 14155776
    s_and_b32 s45, s3, 1
    s_lshl_b32 s45, s45, 7
    s_add_u32 s45, s45, s47
    s_lshr_b32 s46, s43, 1
    s_lshl_b32 s48, s46, 6
    s_add_u32 s98, s45, s48
    s_mulk_i32 s46, 28
    s_add_u32 s45, s45, s46
    s_and_b32 s46, s43, 1
    s_lshl_b32 s46, s46, 6
    s_add_u32 s100, s45, s46
    s_lshl_b32 s46, s43, 6
    s_add_u32 s99, s47, s46
    s_lshr_b32 s44, s43, 1
    v_add_u32 v17, 7168, v16
    v_add_u32 v19, 21504, v16
    s_mul_i32 s85, s44, 196608
    s_and_b32 s84, s3, 3
    s_cmp_eq_u32 s40, 3
    s_cselect_b32 s84, s84, 0
    s_xor_b32 s84, s84, s40
    s_and_b32 s84, s84, 3
    s_lshl_b32 s84, s84, 12
    s_mov_b32 s54, 0x6543e210
    s_mov_b32 s55, 0xdcbaf987
    s_lshl_b32 s42, s42, 2
    s_lshr_b64 s[54:55], s[54:55], s42
    s_and_b32 s42, s54, 15
    s_min_u32 s47, s42, 13
    s_and_b32 s87, s3, 0
    s_xor_b32 s87, s87, s47
    s_and_b32 s87, s87, 3
    s_lshl_b32 s86, s47, 8
    s_mul_i32 s88, s44, 851968
    s_add_u32 s89, s88, 65536
    s_lshl2_add_u32 s90, s41, s43
    s_lshl_b32 s45, s43, 5
    v_add_u32_e64 v5, s45, v23
    v_mul_u32_u24 v5, 3584, v5
    v_add_u32 v40, v5, v22
    s_cmp_lt_u32 s42, 14
    s_cselect_b32 s45, 0, 1073741824
    v_add_u32 v40, s45, v40
    v_add_u32 v41, 27648, v40
    v_add_u32 v42, 55296, v40
    v_add_u32 v43, 82944, v40
    s_and_b32 s45, s3, 3
    s_cmp_eq_u32 s40, 3
    s_cselect_b32 s45, s45, 0
    s_lshl1_add_u32 s45, s45, s40
    s_cmp_ge_u32 s45, 7
    s_cselect_b32 s46, 7, 0
    s_sub_u32 s45, s45, s46
    s_mov_b32 s54, 0x6543210
    s_mov_b32 s55, 0x10654321
    s_lshl_b32 s45, s45, 2
    s_lshr_b64 s[54:55], s[54:55], s45
    s_bfe_u32 s45, s54, 0x40000
    s_lshl_b32 s91, s45, 13
    s_bfe_u32 s45, s54, 0x40004
    s_lshl_b32 s92, s45, 13
    s_bfe_u32 s45, s54, 0x40008
    s_lshl_b32 s93, s45, 13
    s_bfe_u32 s45, s54, 0x4000c
    s_lshl_b32 s94, s45, 13
    s_bfe_u32 s45, s54, 0x40010
    s_lshl_b32 s95, s45, 13
    s_bfe_u32 s45, s54, 0x40014
    s_lshl_b32 s96, s45, 13
    s_bfe_u32 s45, s54, 0x40018
    s_lshl_b32 s97, s45, 13
    v_and_b32 v5, 3, v1
    v_lshlrev_b32 v5, 3, v5
    v_and_b32_e64 v6, 8, v1
    v_lshl_add_u32 v5, v6, 3, v5
    v_and_b32_e64 v6, 16, v1
    v_lshl_add_u32 v5, v6, 1, v5
    v_and_b32_e64 v6, 12, v1
    v_lshl_add_u32 v7, v6, 5, v5
    v_lshrrev_b32_e64 v5, 5, v1
    v_lshl_add_u32 v44, v5, 9, v7
    s_lshl_b32 s45, s43, 6
    s_and_b32 s45, s45, 64
    v_xor_b32 v44, s45, v44
    v_xor_b32 v5, v1, v3
    v_and_b32 v5, 1, v5
    v_subrev_u32 v5, 1, v5
    v_and_b32 v39, v5, v36
    v_and_b32 v38, v5, v36
    v_and_b32 v37, v5, v36
    v_and_b32 v36, v5, v36
    s_xor_b32 s49, s53, 320
    s_add_u32 m0, s83, 151552
    s_mulk_i32 s49, 1536
    buffer_load_dwordx4 v31, s[8:11], s49 offen offset:0 lds
    buffer_load_dwordx4 v31, s[8:11], s49 offen offset:1024 lds
    buffer_load_dwordx4 v31, s[8:11], s49 offen offset:2048 lds
    s_waitcnt vmcnt(7)
    s_barrier
    s_xor_b32 s49, s53, 384
    s_add_u32 m0, s83, 90112
    s_mulk_i32 s49, 1536
    buffer_load_dwordx4 v31, s[8:11], s49 offen offset:0 lds
    buffer_load_dwordx4 v31, s[8:11], s49 offen offset:1024 lds
    buffer_load_dwordx4 v31, s[8:11], s49 offen offset:2048 lds
    s_xor_b32 s49, s53, 448
    s_add_u32 m0, s83, 102400
    s_mulk_i32 s49, 1536
    buffer_load_dwordx4 v31, s[8:11], s49 offen offset:0 lds
    buffer_load_dwordx4 v31, s[8:11], s49 offen offset:1024 lds
    buffer_load_dwordx4 v31, s[8:11], s49 offen offset:2048 lds
    s_waitcnt vmcnt(6)
    s_barrier
    s_xor_b32 s49, s53, 512
    s_add_u32 m0, s83, 114688
    s_mulk_i32 s49, 1536
    buffer_load_dwordx4 v31, s[8:11], s49 offen offset:0 lds
    buffer_load_dwordx4 v31, s[8:11], s49 offen offset:1024 lds
    buffer_load_dwordx4 v31, s[8:11], s49 offen offset:2048 lds
    s_xor_b32 s49, s53, 576
    s_add_u32 m0, s83, 126976
    s_mulk_i32 s49, 1536
    buffer_load_dwordx4 v31, s[8:11], s49 offen offset:0 lds
    buffer_load_dwordx4 v31, s[8:11], s49 offen offset:1024 lds
    buffer_load_dwordx4 v31, s[8:11], s49 offen offset:2048 lds
    s_xor_b32 s49, s84, 0
    s_lshl4_add_u32 s49, s49, s85
    s_add_u32 m0, s50, 8192
    s_nop 0
    buffer_load_dwordx4 v16, s[20:23], s49 offen offset:0 lds
    buffer_load_dwordx4 v17, s[20:23], s49 offen offset:1024 lds
    buffer_load_dwordx4 v18, s[20:23], s49 offen offset:2048 lds
    buffer_load_dwordx4 v19, s[20:23], s49 offen offset:3072 lds
    s_waitcnt vmcnt(10)
    s_barrier
    s_xor_b32 s49, s53, 640
    s_add_u32 m0, s83, 139264
    s_mulk_i32 s49, 1536
    s_nop 0
    buffer_load_dwordx4 v31, s[8:11], s49 offen offset:0 lds
    buffer_load_dwordx4 v31, s[8:11], s49 offen offset:1024 lds
    buffer_load_dwordx4 v31, s[8:11], s49 offen offset:2048 lds
    s_xor_b32 s49, s53, 704
    s_add_u32 m0, s83, 151552
    s_mulk_i32 s49, 1536
    buffer_load_dwordx4 v31, s[8:11], s49 offen offset:0 lds
    buffer_load_dwordx4 v31, s[8:11], s49 offen offset:1024 lds
    buffer_load_dwordx4 v31, s[8:11], s49 offen offset:2048 lds
    s_waitcnt vmcnt(10)
    s_barrier
    s_xor_b32 s49, s53, 768
    s_add_u32 m0, s83, 90112
    s_mulk_i32 s49, 1536
    buffer_load_dwordx4 v31, s[8:11], s49 offen offset:0 lds
    buffer_load_dwordx4 v31, s[8:11], s49 offen offset:1024 lds
    buffer_load_dwordx4 v31, s[8:11], s49 offen offset:2048 lds
    s_xor_b32 s49, s53, 832
    s_add_u32 m0, s83, 102400
    s_mulk_i32 s49, 1536
    s_nop 0
    buffer_load_dwordx4 v31, s[8:11], s49 offen offset:0 lds
    buffer_load_dwordx4 v31, s[8:11], s49 offen offset:1024 lds
    buffer_load_dwordx4 v31, s[8:11], s49 offen offset:2048 lds
    s_xor_b32 s49, s84, 4096
    s_lshl4_add_u32 s49, s49, s85
    s_add_u32 m0, s50, 24576
    s_nop 0
    buffer_load_dwordx4 v16, s[20:23], s49 offen offset:0 lds
    buffer_load_dwordx4 v17, s[20:23], s49 offen offset:1024 lds
    buffer_load_dwordx4 v18, s[20:23], s49 offen offset:2048 lds
    buffer_load_dwordx4 v19, s[20:23], s49 offen offset:3072 lds
    s_waitcnt vmcnt(10)
    s_barrier
    s_xor_b32 s49, s53, 896
    s_add_u32 m0, s83, 114688
    s_mulk_i32 s49, 1536
    s_nop 0
    buffer_load_dwordx4 v31, s[8:11], s49 offen offset:0 lds
    buffer_load_dwordx4 v31, s[8:11], s49 offen offset:1024 lds
    buffer_load_dwordx4 v31, s[8:11], s49 offen offset:2048 lds
    s_xor_b32 s49, s53, 960
    s_add_u32 m0, s83, 126976
    s_mulk_i32 s49, 1536
    buffer_load_dwordx4 v31, s[8:11], s49 offen offset:0 lds
    buffer_load_dwordx4 v31, s[8:11], s49 offen offset:1024 lds
    buffer_load_dwordx4 v31, s[8:11], s49 offen offset:2048 lds
    s_waitcnt vmcnt(10)
    s_barrier
    s_xor_b32 s49, s84, 8192
    s_lshl4_add_u32 s49, s49, s85
    s_add_u32 m0, s50, 40960
    s_nop 0
    s_nop 0
    buffer_load_dwordx4 v16, s[20:23], s49 offen offset:0 lds
    buffer_load_dwordx4 v17, s[20:23], s49 offen offset:1024 lds
    buffer_load_dwordx4 v18, s[20:23], s49 offen offset:2048 lds
    buffer_load_dwordx4 v19, s[20:23], s49 offen offset:3072 lds
    s_xor_b32 s49, s84, 12288
    s_lshl4_add_u32 s49, s49, s85
    s_add_u32 m0, s50, 139264
    s_nop 0
    buffer_load_dwordx4 v16, s[20:23], s49 offen offset:0 lds
    buffer_load_dwordx4 v17, s[20:23], s49 offen offset:1024 lds
    buffer_load_dwordx4 v18, s[20:23], s49 offen offset:2048 lds
    buffer_load_dwordx4 v19, s[20:23], s49 offen offset:3072 lds
    s_waitcnt vmcnt(8)
    s_barrier
    s_waitcnt vmcnt(4)
    s_waitcnt vmcnt(0)
    s_barrier
    s_xor_b32 s49, s87, 0
    s_mul_i32 s49, s49, 458752
    s_add_u32 s49, s49, s86
    s_add_u32 m0, s50, 90112
    s_nop 0
    buffer_load_dwordx4 v40, s[24:27], s49 offen offset:0 lds
    buffer_load_dwordx4 v41, s[24:27], s49 offen offset:1024 lds
    buffer_load_dwordx4 v42, s[24:27], s49 offen offset:2048 lds
    buffer_load_dwordx4 v43, s[24:27], s49 offen offset:3072 lds
    s_xor_b32 s49, s87, 0
    s_mul_i32 s49, s49, 458752
    s_add_u32 s49, s49, s86
    s_addk_i32 s49, 128
    s_add_u32 m0, s50, 57344
    s_nop 0
    buffer_load_dwordx4 v40, s[24:27], s49 offen offset:0 lds
    buffer_load_dwordx4 v41, s[24:27], s49 offen offset:1024 lds
    buffer_load_dwordx4 v42, s[24:27], s49 offen offset:2048 lds
    buffer_load_dwordx4 v43, s[24:27], s49 offen offset:3072 lds
    s_xor_b32 s49, s87, 1
    s_mul_i32 s49, s49, 458752
    s_add_u32 s49, s49, s86
    s_add_u32 m0, s50, 73728
    s_nop 0
    s_nop 0
    buffer_load_dwordx4 v40, s[24:27], s49 offen offset:0 lds
    buffer_load_dwordx4 v41, s[24:27], s49 offen offset:1024 lds
    buffer_load_dwordx4 v42, s[24:27], s49 offen offset:2048 lds
    buffer_load_dwordx4 v43, s[24:27], s49 offen offset:3072 lds
    s_barrier
    s_xor_b32 s49, s87, 1
    s_mul_i32 s49, s49, 458752
    s_add_u32 s49, s49, s86
    s_addk_i32 s49, 128
    s_add_u32 m0, s50, 106496
    s_nop 0
    s_nop 0
    buffer_load_dwordx4 v40, s[24:27], s49 offen offset:0 lds
    buffer_load_dwordx4 v41, s[24:27], s49 offen offset:1024 lds
    buffer_load_dwordx4 v42, s[24:27], s49 offen offset:2048 lds
    buffer_load_dwordx4 v43, s[24:27], s49 offen offset:3072 lds
    s_xor_b32 s49, s87, 2
    s_mul_i32 s49, s49, 458752
    s_add_u32 s49, s49, s86
    s_add_u32 m0, s50, 122880
    s_nop 0
    buffer_load_dwordx4 v40, s[24:27], s49 offen offset:0 lds
    s_barrier
    buffer_load_dwordx4 v41, s[24:27], s49 offen offset:1024 lds
    buffer_load_dwordx4 v42, s[24:27], s49 offen offset:2048 lds
    buffer_load_dwordx4 v43, s[24:27], s49 offen offset:3072 lds
    s_xor_b32 s49, s87, 3
    s_mul_i32 s49, s49, 458752
    s_add_u32 s49, s49, s86
    s_add_u32 m0, s50, 24576
    s_nop 0
    s_nop 0
    buffer_load_dwordx4 v40, s[24:27], s49 offen offset:0 lds
    buffer_load_dwordx4 v41, s[24:27], s49 offen offset:1024 lds
    buffer_load_dwordx4 v42, s[24:27], s49 offen offset:2048 lds
    buffer_load_dwordx4 v43, s[24:27], s49 offen offset:3072 lds
    s_xor_b32 s49, s87, 2
    s_mul_i32 s49, s49, 458752
    s_add_u32 s49, s49, s86
    s_addk_i32 s49, 128
    s_add_u32 m0, s50, 40960
    s_nop 0
    buffer_load_dwordx4 v40, s[24:27], s49 offen offset:0 lds
    buffer_load_dwordx4 v41, s[24:27], s49 offen offset:1024 lds
    buffer_load_dwordx4 v42, s[24:27], s49 offen offset:2048 lds
    buffer_load_dwordx4 v43, s[24:27], s49 offen offset:3072 lds
    s_xor_b32 s49, s87, 3
    s_mul_i32 s49, s49, 458752
    s_add_u32 s49, s49, s86
    s_addk_i32 s49, 128
    s_add_u32 m0, s50, 139264
    s_nop 0
    buffer_load_dwordx4 v40, s[24:27], s49 offen offset:0 lds
    buffer_load_dwordx4 v41, s[24:27], s49 offen offset:1024 lds
    buffer_load_dwordx4 v42, s[24:27], s49 offen offset:2048 lds
    buffer_load_dwordx4 v43, s[24:27], s49 offen offset:3072 lds
    s_waitcnt vmcnt(28)
    s_waitcnt vmcnt(24)
    s_waitcnt vmcnt(20)
    s_waitcnt vmcnt(16)
    s_waitcnt vmcnt(12)
    s_waitcnt vmcnt(4)
    s_waitcnt vmcnt(0)
    s_barrier
    s_cmp_ge_u32 s43, 2
    s_cselect_b32 s45, 3, 5
    s_lshl_b32 s45, s45, 14
    v_add_u32 v10, s45, v44
    ds_read_b64_tr_b16 v[32:33], v10 offset:8192
    ds_read_b64_tr_b16 v[34:35], v10 offset:9216
    ds_read_b64_tr_b16 v[48:49], v10 offset:10240
    ds_read_b64_tr_b16 v[50:51], v10 offset:11264
    ds_read_b64_tr_b16 v[52:53], v10 offset:12288
    ds_read_b64_tr_b16 v[54:55], v10 offset:13312
    ds_read_b64_tr_b16 v[56:57], v10 offset:14336
    ds_read_b64_tr_b16 v[58:59], v10 offset:15360
    ds_read_b64_tr_b16 v[60:61], v10 offset:16384
    ds_read_b64_tr_b16 v[62:63], v10 offset:17408
    ds_read_b64_tr_b16 v[64:65], v10 offset:18432
    ds_read_b64_tr_b16 v[66:67], v10 offset:19456
    ds_read_b64_tr_b16 v[68:69], v10 offset:20480
    ds_read_b64_tr_b16 v[70:71], v10 offset:21504
    ds_read_b64_tr_b16 v[72:73], v10 offset:22528
    ds_read_b64_tr_b16 v[74:75], v10 offset:23552
    s_waitcnt lgkmcnt(0)
    v_mfma_f32_16x16x32_bf16 v[76:79], v[36:39], v[32:35], 0
    s_cmp_ge_u32 s43, 2
    s_cselect_b32 s45, 6, 4
    s_lshl_b32 s45, s45, 14
    v_add_u32_e64 v10, s45, v44
    ds_read_b64_tr_b16 v[100:101], v10 offset:8192
    ds_read_b64_tr_b16 v[102:103], v10 offset:9216
    ds_read_b64_tr_b16 v[104:105], v10 offset:10240
    ds_read_b64_tr_b16 v[106:107], v10 offset:11264
    ds_read_b64_tr_b16 v[108:109], v10 offset:12288
    ds_read_b64_tr_b16 v[110:111], v10 offset:13312
    ds_read_b64_tr_b16 v[112:113], v10 offset:14336
    ds_read_b64_tr_b16 v[114:115], v10 offset:15360
    ds_read_b64_tr_b16 v[116:117], v10 offset:16384
    ds_read_b64_tr_b16 v[118:119], v10 offset:17408
    ds_read_b64_tr_b16 v[120:121], v10 offset:18432
    ds_read_b64_tr_b16 v[122:123], v10 offset:19456
    ds_read_b64_tr_b16 v[124:125], v10 offset:20480
    ds_read_b64_tr_b16 v[126:127], v10 offset:21504
    ds_read_b64_tr_b16 v[128:129], v10 offset:22528
    ds_read_b64_tr_b16 v[130:131], v10 offset:23552
    v_mfma_f32_16x16x32_bf16 v[80:83], v[36:39], v[48:51], 0
    v_mfma_f32_16x16x32_bf16 v[76:79], v[36:39], v[52:55], v[76:79]
    v_mfma_f32_16x16x32_bf16 v[80:83], v[36:39], v[56:59], v[80:83]
    v_mfma_f32_16x16x32_bf16 v[76:79], v[36:39], v[60:63], v[76:79]
    v_mfma_f32_16x16x32_bf16 v[80:83], v[36:39], v[64:67], v[80:83]
    v_mfma_f32_16x16x32_bf16 v[76:79], v[36:39], v[68:71], v[76:79]
    v_mfma_f32_16x16x32_bf16 v[80:83], v[36:39], v[72:75], v[80:83]
    s_waitcnt lgkmcnt(0)
    v_mfma_f32_16x16x32_bf16 v[76:79], v[36:39], v[100:103], v[76:79]
    s_cmp_ge_u32 s43, 2
    s_cselect_b32 s45, 2, 7
    s_lshl_b32 s45, s45, 14
    v_add_u32_e64 v10, s45, v44
    ds_read_b64_tr_b16 v[32:33], v10 offset:8192
    ds_read_b64_tr_b16 v[34:35], v10 offset:9216
    ds_read_b64_tr_b16 v[48:49], v10 offset:10240
    ds_read_b64_tr_b16 v[50:51], v10 offset:11264
    ds_read_b64_tr_b16 v[52:53], v10 offset:12288
    ds_read_b64_tr_b16 v[54:55], v10 offset:13312
    ds_read_b64_tr_b16 v[56:57], v10 offset:14336
    ds_read_b64_tr_b16 v[58:59], v10 offset:15360
    ds_read_b64_tr_b16 v[60:61], v10 offset:16384
    ds_read_b64_tr_b16 v[62:63], v10 offset:17408
    ds_read_b64_tr_b16 v[64:65], v10 offset:18432
    ds_read_b64_tr_b16 v[66:67], v10 offset:19456
    ds_read_b64_tr_b16 v[68:69], v10 offset:20480
    ds_read_b64_tr_b16 v[70:71], v10 offset:21504
    ds_read_b64_tr_b16 v[72:73], v10 offset:22528
    ds_read_b64_tr_b16 v[74:75], v10 offset:23552
    v_mfma_f32_16x16x32_bf16 v[80:83], v[36:39], v[104:107], v[80:83]
    v_mfma_f32_16x16x32_bf16 v[76:79], v[36:39], v[108:111], v[76:79]
    v_mfma_f32_16x16x32_bf16 v[80:83], v[36:39], v[112:115], v[80:83]
    v_mfma_f32_16x16x32_bf16 v[76:79], v[36:39], v[116:119], v[76:79]
    v_mfma_f32_16x16x32_bf16 v[80:83], v[36:39], v[120:123], v[80:83]
    v_mfma_f32_16x16x32_bf16 v[76:79], v[36:39], v[124:127], v[76:79]
    v_mfma_f32_16x16x32_bf16 v[80:83], v[36:39], v[128:131], v[80:83]
    s_waitcnt lgkmcnt(0)
    v_mfma_f32_16x16x32_bf16 v[76:79], v[36:39], v[32:35], v[76:79]
    s_cmp_ge_u32 s43, 2
    s_cselect_b32 s45, 8, 1
    s_lshl_b32 s45, s45, 14
    v_add_u32_e64 v10, s45, v44
    ds_read_b64_tr_b16 v[100:101], v10 offset:8192
    ds_read_b64_tr_b16 v[102:103], v10 offset:9216
    ds_read_b64_tr_b16 v[104:105], v10 offset:10240
    ds_read_b64_tr_b16 v[106:107], v10 offset:11264
    ds_read_b64_tr_b16 v[108:109], v10 offset:12288
    ds_read_b64_tr_b16 v[110:111], v10 offset:13312
    ds_read_b64_tr_b16 v[112:113], v10 offset:14336
    ds_read_b64_tr_b16 v[114:115], v10 offset:15360
    ds_read_b64_tr_b16 v[116:117], v10 offset:16384
    ds_read_b64_tr_b16 v[118:119], v10 offset:17408
    ds_read_b64_tr_b16 v[120:121], v10 offset:18432
    ds_read_b64_tr_b16 v[122:123], v10 offset:19456
    ds_read_b64_tr_b16 v[124:125], v10 offset:20480
    ds_read_b64_tr_b16 v[126:127], v10 offset:21504
    ds_read_b64_tr_b16 v[128:129], v10 offset:22528
    ds_read_b64_tr_b16 v[130:131], v10 offset:23552
    v_mfma_f32_16x16x32_bf16 v[80:83], v[36:39], v[48:51], v[80:83]
    v_mfma_f32_16x16x32_bf16 v[76:79], v[36:39], v[52:55], v[76:79]
    v_mfma_f32_16x16x32_bf16 v[80:83], v[36:39], v[56:59], v[80:83]
    v_mfma_f32_16x16x32_bf16 v[76:79], v[36:39], v[60:63], v[76:79]
    v_mfma_f32_16x16x32_bf16 v[80:83], v[36:39], v[64:67], v[80:83]
    v_mfma_f32_16x16x32_bf16 v[76:79], v[36:39], v[68:71], v[76:79]
    v_mfma_f32_16x16x32_bf16 v[80:83], v[36:39], v[72:75], v[80:83]
    s_waitcnt lgkmcnt(0)
    s_nop 0
    v_mfma_f32_16x16x32_bf16 v[76:79], v[36:39], v[100:103], v[76:79]
    v_mfma_f32_16x16x32_bf16 v[80:83], v[36:39], v[104:107], v[80:83]
    v_mfma_f32_16x16x32_bf16 v[76:79], v[36:39], v[108:111], v[76:79]
    v_mfma_f32_16x16x32_bf16 v[80:83], v[36:39], v[112:115], v[80:83]
    v_mfma_f32_16x16x32_bf16 v[76:79], v[36:39], v[116:119], v[76:79]
    v_mfma_f32_16x16x32_bf16 v[80:83], v[36:39], v[120:123], v[80:83]
    v_mfma_f32_16x16x32_bf16 v[76:79], v[36:39], v[124:127], v[76:79]
    v_mfma_f32_16x16x32_bf16 v[80:83], v[36:39], v[128:131], v[80:83]
    s_lshl_b32 s45, s43, 7
    s_addk_i32 s45, 7424
    v_lshl_add_u32 v12, v2, 2, s45
    s_nop 4
    v_add_f32 v76, v76, v80
    v_add_f32_e64 v77, v77, v81
    ds_write2_b32 v12, v76, v77 offset0:0 offset1:16
    s_xor_b32 s49, s84, 0
    s_lshl4_add_u32 s49, s49, s85
    s_add_u32 m0, s50, 8192
    s_nop 0
    s_nop 0
    buffer_load_dwordx4 v16, s[12:15], s49 offen offset:0 lds
    buffer_load_dwordx4 v17, s[12:15], s49 offen offset:1024 lds
    buffer_load_dwordx4 v18, s[12:15], s49 offen offset:2048 lds
    buffer_load_dwordx4 v19, s[12:15], s49 offen offset:3072 lds
    s_waitcnt lgkmcnt(0)
    s_barrier
    s_lshl_b32 s45, s90, 12
    s_add_u32 s45, s45, 13631488
    v_and_b32 v7, 1073741824, v40
    v_or_b32_e64 v7, v7, v4
    buffer_load_dwordx4 v[84:87], v7, s[36:39], s45 offen offset:0 sc1
    buffer_load_dwordx4 v[88:91], v7, s[36:39], s45 offen offset:1024 sc1
    buffer_load_dwordx4 v[92:95], v7, s[36:39], s45 offen offset:2048 sc1
    buffer_load_dwordx4 v[96:99], v7, s[36:39], s45 offen offset:3072 sc1
    s_xor_b32 s49, s84, 4096
    s_lshl4_add_u32 s49, s49, s85
    s_add_u32 m0, s50, 90112
    s_nop 0
    buffer_load_dwordx4 v16, s[12:15], s49 offen offset:0 lds
    buffer_load_dwordx4 v17, s[12:15], s49 offen offset:1024 lds
    buffer_load_dwordx4 v18, s[12:15], s49 offen offset:2048 lds
    buffer_load_dwordx4 v19, s[12:15], s49 offen offset:3072 lds
    s_xor_b32 s49, s84, 8192
    s_lshl4_add_u32 s49, s49, s85
    s_add_u32 m0, s50, 57344
    s_nop 0
    buffer_load_dwordx4 v16, s[12:15], s49 offen offset:0 lds
    buffer_load_dwordx4 v17, s[12:15], s49 offen offset:1024 lds
    buffer_load_dwordx4 v18, s[12:15], s49 offen offset:2048 lds
    buffer_load_dwordx4 v19, s[12:15], s49 offen offset:3072 lds
    s_barrier
    s_setprio 2
    s_waitcnt vmcnt(8)
    v_add_f32 v84, v84, v96
    v_add_f32 v85, v85, v97
    v_add_f32 v86, v86, v98
    v_add_f32 v87, v87, v99
    v_add_f32 v84, v84, v92
    v_add_f32 v85, v85, v93
    v_add_f32 v86, v86, v94
    v_add_f32 v87, v87, v95
    v_add_f32 v84, v84, v88
    v_add_f32 v85, v85, v89
    v_add_f32 v86, v86, v90
    v_add_f32 v87, v87, v91
    s_lshl_b32 s46, s43, 10
    s_addk_i32 s46, 3328
    v_add_u32 v5, s46, v4
    ds_write_b128 v5, v[84:87]
    v_and_b32_e64 v6, 31, v1
    v_lshl_add_u32 v6, v6, 2, s46
    ds_read2_b32 v[88:89], v6 offset0:0 offset1:32
    ds_read2_b32 v[90:91], v6 offset0:64 offset1:96
    ds_read2_b32 v[92:93], v6 offset0:128 offset1:160
    ds_read2_b32 v[94:95], v6 offset0:192 offset1:224
    s_waitcnt lgkmcnt(0)
    v_add_f32 v86, v92, v94
    v_add_f32 v84, v88, v90
    v_add_f32 v87, v93, v95
    v_add_f32 v85, v89, v91
    v_add_f32 v84, v84, v86
    v_add_f32_e64 v85, v85, v87
    v_mul_f32 v96, 0x3b000000, v84
    v_mul_f32 v85, 0x3b000000, v85
    v_fma_f32 v85, -v96, v96, v85
    v_max_f32_e64 v85, 0, v85
    v_add_f32 v85, 0x3727c5ac, v85
    v_rsq_f32 v86, v85
    s_nop 0
    v_mul_f32 v97, 0xc0135761, v86
    v_mul_f32 v87, v86, v86
    v_mul_f32 v87, v87, v86
    v_mul_f32 v98, 0xbdd2d3e8, v87
    v_mul_f32_e64 v99, v85, v86
    ds_write_b128 v5, v[96:99]
    s_setprio 0
    s_xor_b32 s49, s84, 12288
    s_lshl4_add_u32 s49, s49, s85
    s_add_u32 m0, s50, 73728
    s_nop 0
    s_nop 0
    buffer_load_dwordx4 v16, s[12:15], s49 offen offset:0 lds
    buffer_load_dwordx4 v17, s[12:15], s49 offen offset:1024 lds
    buffer_load_dwordx4 v18, s[12:15], s49 offen offset:2048 lds
    buffer_load_dwordx4 v19, s[12:15], s49 offen offset:3072 lds
    s_lshl4_add_u32 s49, s91, s88
    s_add_u32 m0, s50, 106496
    s_nop 0
    buffer_load_dwordx4 v16, s[28:31], s49 offen offset:0 lds
    buffer_load_dwordx4 v17, s[28:31], s49 offen offset:1024 lds
    buffer_load_dwordx4 v18, s[28:31], s49 offen offset:2048 lds
    buffer_load_dwordx4 v19, s[28:31], s49 offen offset:3072 lds
    s_waitcnt lgkmcnt(0)
    s_barrier
    s_lshl4_add_u32 s49, s92, s88
    s_add_u32 m0, s50, 122880
    s_nop 0
    buffer_load_dwordx4 v16, s[28:31], s49 offen offset:0 lds
    buffer_load_dwordx4 v17, s[28:31], s49 offen offset:1024 lds
    s_barrier
    buffer_load_dwordx4 v18, s[28:31], s49 offen offset:2048 lds
    buffer_load_dwordx4 v19, s[28:31], s49 offen offset:3072 lds
    s_lshl4_add_u32 s49, s93, s88
    s_add_u32 m0, s50, 24576
    s_nop 0
    s_nop 0
    buffer_load_dwordx4 v16, s[28:31], s49 offen offset:0 lds
    buffer_load_dwordx4 v17, s[28:31], s49 offen offset:1024 lds
    buffer_load_dwordx4 v18, s[28:31], s49 offen offset:2048 lds
    buffer_load_dwordx4 v19, s[28:31], s49 offen offset:3072 lds
    s_barrier
    s_lshl4_add_u32 s49, s94, s88
    s_add_u32 m0, s50, 40960
    s_nop 0
    buffer_load_dwordx4 v16, s[28:31], s49 offen offset:0 lds
    buffer_load_dwordx4 v17, s[28:31], s49 offen offset:1024 lds
    s_waitcnt vmcnt(22)
    s_barrier
    buffer_load_dwordx4 v18, s[28:31], s49 offen offset:2048 lds
    s_barrier
    buffer_load_dwordx4 v19, s[28:31], s49 offen offset:3072 lds
    s_lshl4_add_u32 s49, s95, s88
    s_add_u32 m0, s50, 139264
    s_nop 0
    buffer_load_dwordx4 v16, s[28:31], s49 offen offset:0 lds
    buffer_load_dwordx4 v17, s[28:31], s49 offen offset:1024 lds
    buffer_load_dwordx4 v18, s[28:31], s49 offen offset:2048 lds
    buffer_load_dwordx4 v19, s[28:31], s49 offen offset:3072 lds
    s_barrier
    s_lshl4_add_u32 s49, s96, s88
    s_add_u32 m0, s50, 8192
    s_nop 0
    s_nop 0
    buffer_load_dwordx4 v16, s[28:31], s49 offen offset:0 lds
    buffer_load_dwordx4 v17, s[28:31], s49 offen offset:1024 lds
    buffer_load_dwordx4 v18, s[28:31], s49 offen offset:2048 lds
    buffer_load_dwordx4 v19, s[28:31], s49 offen offset:3072 lds
    s_lshl4_add_u32 s49, s97, s88
    s_add_u32 m0, s50, 90112
    s_nop 0
    buffer_load_dwordx4 v16, s[28:31], s49 offen offset:0 lds
    buffer_load_dwordx4 v17, s[28:31], s49 offen offset:1024 lds
    buffer_load_dwordx4 v18, s[28:31], s49 offen offset:2048 lds
    buffer_load_dwordx4 v19, s[28:31], s49 offen offset:3072 lds
    s_waitcnt vmcnt(32)
    s_barrier
    s_waitcnt vmcnt(28)
    s_barrier
    s_lshl4_add_u32 s49, s91, s89
    s_add_u32 m0, s50, 57344
    s_nop 0
    buffer_load_dwordx4 v16, s[28:31], s49 offen offset:0 lds
    buffer_load_dwordx4 v17, s[28:31], s49 offen offset:1024 lds
    s_waitcnt vmcnt(26)
    s_barrier
    buffer_load_dwordx4 v18, s[28:31], s49 offen offset:2048 lds
    buffer_load_dwordx4 v19, s[28:31], s49 offen offset:3072 lds
    s_lshl4_add_u32 s49, s92, s89
    s_add_u32 m0, s50, 73728
    s_nop 0
    buffer_load_dwordx4 v16, s[28:31], s49 offen offset:0 lds
    buffer_load_dwordx4 v17, s[28:31], s49 offen offset:1024 lds
    s_waitcnt vmcnt(26)
    s_barrier
    buffer_load_dwordx4 v18, s[28:31], s49 offen offset:2048 lds
    buffer_load_dwordx4 v19, s[28:31], s49 offen offset:3072 lds
    s_waitcnt vmcnt(24)
    s_barrier
    s_waitcnt vmcnt(20)
    s_barrier
    s_lshl4_add_u32 s49, s93, s89
    s_add_u32 m0, s50, 106496
    s_nop 0
    buffer_load_dwordx4 v16, s[28:31], s49 offen offset:0 lds
    s_waitcnt vmcnt(17)
    s_barrier
    buffer_load_dwordx4 v17, s[28:31], s49 offen offset:1024 lds
    buffer_load_dwordx4 v18, s[28:31], s49 offen offset:2048 lds
    buffer_load_dwordx4 v19, s[28:31], s49 offen offset:3072 lds
    s_lshl4_add_u32 s49, s94, s89
    s_add_u32 m0, s50, 122880
    s_nop 0
    buffer_load_dwordx4 v16, s[28:31], s49 offen offset:0 lds
    buffer_load_dwordx4 v17, s[28:31], s49 offen offset:1024 lds
    s_waitcnt vmcnt(18)
    s_barrier
    buffer_load_dwordx4 v18, s[28:31], s49 offen offset:2048 lds
    buffer_load_dwordx4 v19, s[28:31], s49 offen offset:3072 lds
    s_lshl4_add_u32 s49, s95, s89
    s_add_u32 m0, s50, 24576
    s_nop 0
    buffer_load_dwordx4 v16, s[28:31], s49 offen offset:0 lds
    buffer_load_dwordx4 v17, s[28:31], s49 offen offset:1024 lds
    buffer_load_dwordx4 v18, s[28:31], s49 offen offset:2048 lds
    s_waitcnt vmcnt(19)
    s_barrier
    buffer_load_dwordx4 v19, s[28:31], s49 offen offset:3072 lds
    s_lshl4_add_u32 s49, s96, s89
    s_add_u32 m0, s50, 40960
    s_nop 0
    buffer_load_dwordx4 v16, s[28:31], s49 offen offset:0 lds
    buffer_load_dwordx4 v17, s[28:31], s49 offen offset:1024 lds
    buffer_load_dwordx4 v18, s[28:31], s49 offen offset:2048 lds
    buffer_load_dwordx4 v19, s[28:31], s49 offen offset:3072 lds
    s_waitcnt vmcnt(20)
    s_barrier
    s_waitcnt vmcnt(16)
    s_barrier
    s_waitcnt vmcnt(12)
    s_barrier
    s_lshl4_add_u32 s49, s97, s89
    s_add_u32 m0, s50, 139264
    s_nop 0
    buffer_load_dwordx4 v16, s[28:31], s49 offen offset:0 lds
    buffer_load_dwordx4 v17, s[28:31], s49 offen offset:1024 lds
    buffer_load_dwordx4 v18, s[28:31], s49 offen offset:2048 lds
    s_waitcnt vmcnt(11)
    s_barrier
    buffer_load_dwordx4 v19, s[28:31], s49 offen offset:3072 lds
    s_waitcnt vmcnt(8)
    s_barrier
    s_waitcnt vmcnt(4)
    s_barrier
    s_waitcnt vmcnt(0)
    s_barrier
    s_endpgm
L_COMPUTE:
    s_getpc_b64 s[38:39]
    v_lshlrev_b32_e64 v6, 5, v0
    v_and_b32 v6, 0x1fff, v6
    global_load_dword v9, v6, s[38:39]
    s_load_dwordx2 s[8:9], s[0:1], 64
    s_load_dwordx2 s[12:13], s[0:1], 72
    s_load_dwordx2 s[20:21], s[0:1], 80
    s_setprio 1
    s_and_b32 s43, s43, 3
    v_and_b32 v4, 63, v0
    v_lshlrev_b32_e64 v5, 4, v4
    s_add_u32 s25, s78, 0
    s_and_b32 s25, s25, 0x300
    s_xor_b32 s33, s25, s53
    s_mulk_i32 s33, 81
    s_add_u32 s25, s78, 256
    s_and_b32 s25, s25, 0x300
    s_xor_b32 s41, s25, s53
    s_mulk_i32 s41, 81
    s_add_u32 s25, s78, 512
    s_and_b32 s25, s25, 0x300
    s_xor_b32 s42, s25, s53
    s_mulk_i32 s42, 81
    s_add_u32 s25, s78, 768
    s_and_b32 s25, s25, 0x300
    s_xor_b32 s44, s25, s53
    s_mulk_i32 s44, 81
    s_lshl_b32 s25, s40, 2
    s_and_b32 s25, s25, 24
    s_lshr_b32 s25, 0x100c0f0d, s25
    s_and_b32 s25, s25, 31
    v_add_u32 v6, s25, v2
    v_lshlrev_b32 v159, 3, v6
    v_lshlrev_b32 v7, 1, v6
    v_bitop3_b32 v7, v7, v3, 15 bitop3:0x28
    v_lshl_add_u32 v7, v6, 4, v7
    v_lshlrev_b32_e64 v7, 4, v7
    v_add_u32 v120, 7168, v7
    v_xor_b32_e64 v121, 64, v120
    v_xor_b32 v122, 128, v120
    v_xor_b32 v123, 192, v120
    v_and_b32 v6, 3, v4
    v_lshlrev_b32 v6, 3, v6
    v_and_b32_e64 v7, 8, v4
    v_lshl_add_u32 v6, v7, 3, v6
    v_and_b32_e64 v7, 16, v4
    v_lshl_add_u32 v6, v7, 1, v6
    v_and_b32_e64 v7, 12, v4
    v_lshl_add_u32 v13, v7, 5, v6
    s_lshl_b32 s25, s43, 5
    v_xor_b32 v6, s25, v13
    v_lshl_add_u32 v11, v3, 10, v6
    v_add_u32 v11, 98304, v11
    v_mul_u32_u24 v8, 3072, v3
    v_add_u32_e64 v12, v8, v6
    v_add_u32 v12, 90112, v12
    v_mov_b32 v124, 0x3f803f80
    v_mov_b32 v125, v124
    v_mov_b64_e64 v[126:127], v[124:125]
    s_waitcnt lgkmcnt(0)
    s_mov_b32 s10, 2097152
    s_mov_b32 s11, 0x20000
    s_mov_b32 s14, 256
    s_mov_b32 s15, 0x20000
    s_mov_b32 s22, 15728640
    s_mov_b32 s23, 0x20000
    v_add_u32 v6, 14, v2
    v_lshlrev_b32 v7, 1, v6
    v_bitop3_b32 v7, v7, v3, 15 bitop3:0x28
    v_lshl_add_u32 v7, v6, 4, v7
    v_lshlrev_b32_e64 v7, 4, v7
    v_add_u32 v144, 7168, v7
    v_xor_b32_e64 v145, 64, v144
    v_xor_b32 v146, 128, v144
    v_xor_b32 v147, 192, v144
    v_subrev_u32_e64 v6, 2, v2
    v_min_u32 v6, 80, v6
    v_lshlrev_b32_e64 v7, 1, v6
    v_bitop3_b32 v7, v7, v3, 15 bitop3:0x28
    v_lshl_add_u32 v7, v6, 4, v7
    v_lshlrev_b32_e64 v7, 4, v7
    v_add_u32 v148, 7168, v7
    v_xor_b32_e64 v149, 64, v148
    v_xor_b32 v150, 128, v148
    v_xor_b32 v151, 192, v148
    s_mul_i32 s25, s43, 20736
    s_add_u32 s25, s25, 27648
    v_lshl_add_u32 v6, v4, 2, s25
    ds_write_b32 v6, v124
    s_lshr_b32 s6, s3, 1
    s_and_b32 s7, s51, 15
    s_mov_b32 s34, 0xc0135761
    s_mov_b32 s35, 0xbdd2d3e8
    s_lshl4_add_u32 s25, s3, s40
    s_lshl2_add_u32 s25, s25, s43
    s_lshl_b32 s16, s25, 10
    s_and_b32 s5, s51, 16
    v_and_b32 v17, 12, v4
    v_min_u32 v14, 1, v4
    v_lshlrev_b32 v14, 30, v14
    v_mov_b32 v15, 1
    s_mov_b32 s29, 200000
    s_getreg_b32 s4, hwreg(HW_REG_XCC_ID)
    s_and_b32 s4, s4, 7
    s_and_b32 s26, s2, 7
    s_lshl3_add_u32 s4, s4, s26
    s_add_u32 s4, s4, 1
    s_mul_i32 s4, s4, 0x01010101
    s_lshl_b32 s17, s6, 2
    s_lshl_b32 s30, s6, 11
    s_add_u32 s30, s30, 14155776
    s_lshr_b32 s18, s43, 1
    s_and_b32 s19, s43, 1
    s_lshr_b32 s25, s40, 1
    s_lshl_b32 s25, s25, 8
    s_xor_b32 s25, s25, s53
    s_mulk_i32 s25, 81
    s_addk_i32 s25, 7168
    s_lshl_b32 s26, s19, 5
    s_add_u32 s26, s26, 14
    v_and_b32 v6, 31, v4
    v_add_u32 v6, s26, v6
    s_lshl1_add_u32 s27, s40, s18
    s_lshl_b32 s27, s27, 2
    v_lshlrev_b32_e64 v7, 1, v6
    v_bitop3_b32 v7, v7, s27, 15 bitop3:0x28
    v_lshl_add_u32 v7, v6, 4, v7
    v_lshrrev_b32_e64 v8, 5, v4
    v_lshl_add_u32 v7, v7, 1, v8
    v_lshl_add_u32 v18, v7, 3, s25
    v_lshl_add_u32 v20, v8, 10, v13
    v_lshlrev_b32 v19, 3, v6
    s_lshl2_add_u32 s25, s7, s43
    s_lshl2_add_u32 s55, s25, s30
    v_lshlrev_b32 v0, 2, v2
    s_lshl1_add_u32 s46, s3, s19
    s_lshl2_add_u32 s47, s6, s43
    s_mov_b32 s38, 0x6543e210
    s_mov_b32 s39, 0xdcbaf987
    s_lshl_b32 s7, s7, 2
    s_lshr_b64 s[38:39], s[38:39], s7
    s_and_b32 s7, s38, 15
    s_min_u32 s24, s7, 13
    s_and_b32 s25, s3, 1
    s_lshl1_add_u32 s25, s25, s18
    s_lshl_b32 s25, s25, 6
    s_add_u32 s58, s25, s30
    s_and_b32 s54, s3, 3
    s_cmp_eq_u32 s40, 3
    s_cselect_b32 s54, s54, 0
    s_xor_b32 s54, s54, s40
    s_and_b32 s54, s54, 3
    s_lshl_b32 s54, s54, 12
    s_lshl1_add_u32 s26, s46, s18
    s_lshl_b32 s48, s26, 14
    s_add_u32 s48, s48, s54
    s_mul_i32 s26, s26, 57344
    s_add_u32 s50, s26, 6291456
    s_add_u32 s52, s50, 4096
    s_lshl3_add_u32 s25, s46, s40
    s_lshl1_add_u32 s61, s25, s18
    s_and_b32 s25, s61, 63
    s_lshl2_add_u32 s56, s25, s30
    s_lshl_b32 s25, s43, 6
    s_add_u32 s59, s25, s30
    s_lshl2_add_u32 s57, s7, s59
    s_and_b32 s25, s46, 3
    s_lshl_b32 s25, s25, 6
    s_mul_i32 s26, s18, 28
    s_add_u32 s25, s25, s26
    s_add_u32 s60, s25, s30
    s_mul_i32 s25, s47, 14
    s_add_u32 s25, s25, s24
    s_lshl_b32 s25, s25, 13
    s_add_u32 s62, s25, 6291456
    s_and_b32 s26, s3, 0
    s_xor_b32 s26, s26, s24
    s_and_b32 s26, s26, 3
    s_lshl2_add_u32 s25, s47, s26
    s_lshl_b32 s25, s25, 13
    s_add_u32 s49, s25, 4194304
    s_lshl_b32 s32, s43, 12
    s_mul_i32 s25, s18, 8256
    v_xor_b32 v20, s25, v20
    v_xor_b32_e64 v21, 64, v20
    s_and_b32 s25, s3, 3
    s_cmp_eq_u32 s40, 3
    s_cselect_b32 s25, s25, 0
    s_lshl1_add_u32 s25, s25, s40
    s_cmp_ge_u32 s25, 7
    s_cselect_b32 s26, 7, 0
    s_sub_u32 s25, s25, s26
    s_mov_b32 s38, 0x6543210
    s_mov_b32 s39, 0x10654321
    s_lshl_b32 s25, s25, 2
    s_lshr_b64 s[38:39], s[38:39], s25
    s_bfe_u32 s25, s38, 0x40000
    s_lshl_b32 s63, s25, 13
    s_bfe_u32 s25, s38, 0x40004
    s_lshl_b32 s64, s25, 13
    s_bfe_u32 s25, s38, 0x40008
    s_lshl_b32 s65, s25, 13
    s_bfe_u32 s25, s38, 0x4000c
    s_lshl_b32 s66, s25, 13
    s_bfe_u32 s25, s38, 0x40010
    s_lshl_b32 s67, s25, 13
    s_bfe_u32 s25, s38, 0x40014
    s_lshl_b32 s68, s25, 13
    s_bfe_u32 s25, s38, 0x40018
    s_lshl_b32 s69, s25, 13
    v_mov_b64 v[22:23], 0
    v_mov_b64 v[24:25], 0
    v_mov_b64 v[26:27], 0
    v_mov_b64 v[28:29], 0
    v_mov_b64 v[30:31], 0
    ds_write_b128 v22, v[22:25] offset:0
    ds_write_b64 v22, v[22:23] offset:1536
    ds_write_b64 v22, v[22:23] offset:1920
    s_mov_b32 s38, 0x00020002
    s_mov_b32 s39, s38
    v_and_b32_e64 v6, 12, v4
    s_mul_i32 s25, s43, 20
    v_cndmask_b32 v6, v6, 16, s[38:39]
    s_lshl_b32 s27, s25, 8
    s_addk_i32 s27, 7168
    s_add_u32 s25, s25, 2
    v_add3_u32 v6, v6, v3, s25
    v_lshlrev_b32 v157, 3, v6
    v_lshlrev_b32 v158, 2, v6
    v_add_u32 v152, s33, v120
    v_add_u32 v153, s33, v121
    v_add_u32 v154, s33, v122
    v_add_u32 v155, s33, v123
    s_add_u32 s25, s33, s27
    v_add_u32 v156, s25, v5
    s_barrier
    ds_read_b128 v[128:131], v156 offset:0
    ds_read_b128 v[132:135], v156 offset:1024
    ds_read_b128 v[136:139], v156 offset:2048
    ds_read_b128 v[140:143], v156 offset:3072
    ds_read_b128 v[112:115], v156 offset:4096
    ds_read_b64_tr_b16 v[96:97], v11 offset:0
    ds_read_b64_tr_b16 v[98:99], v11 offset:512
    ds_read_b128 v[160:163], v152 offset:0
    ds_read_b128 v[164:167], v152 offset:4096
    ds_read_b128 v[168:171], v152 offset:8192
    ds_read_b128 v[172:175], v152 offset:12288
    ds_read_b64_tr_b16 v[100:101], v11 offset:4096
    ds_read_b64_tr_b16 v[102:103], v11 offset:4608
    s_waitcnt lgkmcnt(8)
    v_dot2c_f32_bf16 v30, v112, v124
    v_dot2c_f32_bf16 v31, v112, v112
    v_dot2c_f32_bf16 v30, v113, v124
    ds_read_b128 v[176:179], v153 offset:0
    v_dot2c_f32_bf16 v31, v113, v113
    v_dot2c_f32_bf16 v30, v114, v124
    ds_read_b128 v[180:183], v153 offset:4096
    v_dot2c_f32_bf16 v31, v114, v114
    v_dot2c_f32_bf16 v30, v115, v124
    v_dot2c_f32_bf16_e64 v31, v115, v115
    ds_read_b128 v[184:187], v153 offset:8192
    v_dot2c_f32_bf16 v28, v140, v124
    v_dot2c_f32_bf16 v29, v140, v140
    ds_read_b128 v[188:191], v153 offset:12288
    v_dot2c_f32_bf16 v28, v141, v124
    v_dot2c_f32_bf16 v29, v141, v141
    v_dot2c_f32_bf16_e64 v28, v142, v124
    ds_read_b64_tr_b16 v[104:105], v11 offset:8192
    v_dot2c_f32_bf16 v29, v142, v142
    v_dot2c_f32_bf16 v28, v143, v124
    ds_read_b64_tr_b16 v[106:107], v11 offset:8704
    v_dot2c_f32_bf16 v29, v143, v143
    v_dot2c_f32_bf16 v26, v136, v124
    v_dot2c_f32_bf16_e64 v27, v136, v136
    ds_read_b128 v[192:195], v154 offset:0
    v_dot2c_f32_bf16 v26, v137, v124
    v_dot2c_f32_bf16 v27, v137, v137
    ds_read_b128 v[196:199], v154 offset:4096
    v_dot2c_f32_bf16 v26, v138, v124
    v_dot2c_f32_bf16 v27, v138, v138
    v_dot2c_f32_bf16_e64 v26, v139, v124
    ds_read_b128 v[200:203], v154 offset:8192
    v_dot2c_f32_bf16 v27, v139, v139
    v_dot2c_f32_bf16 v24, v132, v124
    ds_read_b128 v[204:207], v154 offset:12288
    v_dot2c_f32_bf16 v25, v132, v132
    v_dot2c_f32_bf16 v24, v133, v124
    v_dot2c_f32_bf16_e64 v25, v133, v133
    ds_read_b64_tr_b16 v[108:109], v11 offset:12288
    v_dot2c_f32_bf16 v24, v134, v124
    v_dot2c_f32_bf16 v25, v134, v134
    ds_read_b64_tr_b16 v[110:111], v11 offset:12800
    v_dot2c_f32_bf16 v24, v135, v124
    v_dot2c_f32_bf16 v25, v135, v135
    v_dot2c_f32_bf16_e64 v22, v128, v124
    ds_read_b128 v[208:211], v155 offset:0
    v_dot2c_f32_bf16 v23, v128, v128
    v_dot2c_f32_bf16 v22, v129, v124
    ds_read_b128 v[212:215], v155 offset:4096
    v_dot2c_f32_bf16 v23, v129, v129
    v_dot2c_f32_bf16 v22, v130, v124
    v_dot2c_f32_bf16_e64 v23, v130, v130
    ds_read_b128 v[216:219], v155 offset:8192
    v_dot2c_f32_bf16 v22, v131, v124
    v_dot2c_f32_bf16 v23, v131, v131
    ds_read_b128 v[220:223], v155 offset:12288
    v_add_u32 v152, s41, v120
    v_add_u32 v153, s41, v121
    v_add_u32 v154, s41, v122
    v_add_u32 v155, s41, v123
    s_add_u32 s25, s41, s27
    v_add_u32 v156, s25, v5
    s_barrier
    s_waitcnt lgkmcnt(15)
    v_mfma_f32_16x16x32_bf16 v[44:47], v[96:99], v[172:175], 0
    ds_read_b128 v[128:131], v156 offset:0
    v_mfma_f32_16x16x32_bf16 v[40:43], v[96:99], v[168:171], 0
    ds_read_b128 v[132:135], v156 offset:1024
    v_mfma_f32_16x16x32_bf16 v[36:39], v[96:99], v[164:167], 0
    ds_read_b128 v[136:139], v156 offset:2048
    v_mfma_f32_16x16x32_bf16 v[32:35], v[96:99], v[160:163], 0
    ds_read_b128 v[140:143], v156 offset:3072
    ds_read_b128 v[112:115], v156 offset:4096
    v_mfma_f32_16x16x32_bf16 v[116:119], v[96:99], v[124:127], 0
    ds_read_b64_tr_b16 v[48:49], v11 offset:16384
    s_waitcnt lgkmcnt(15)
    s_nop 0
    v_mfma_f32_16x16x32_bf16 v[44:47], v[100:103], v[188:191], v[44:47]
    ds_read_b64_tr_b16 v[50:51], v11 offset:16896
    v_mfma_f32_16x16x32_bf16 v[40:43], v[100:103], v[184:187], v[40:43]
    ds_read_b128 v[224:227], v152 offset:0
    ds_read_b128 v[228:231], v152 offset:4096
    v_mfma_f32_16x16x32_bf16 v[36:39], v[100:103], v[180:183], v[36:39]
    ds_read_b128 v[232:235], v152 offset:8192
    v_mfma_f32_16x16x32_bf16 v[32:35], v[100:103], v[176:179], v[32:35]
    ds_read_b128 v[236:239], v152 offset:12288
    v_mfma_f32_16x16x32_bf16 v[116:119], v[100:103], v[124:127], v[116:119]
    ds_read_b64_tr_b16 v[52:53], v11 offset:20480
    ds_read_b64_tr_b16 v[54:55], v11 offset:20992
    s_waitcnt lgkmcnt(15)
    s_nop 0
    v_mfma_f32_16x16x32_bf16 v[44:47], v[104:107], v[204:207], v[44:47]
    ds_read_b128 v[240:243], v153 offset:0
    v_mfma_f32_16x16x32_bf16 v[40:43], v[104:107], v[200:203], v[40:43]
    ds_read_b128 v[244:247], v153 offset:4096
    v_mfma_f32_16x16x32_bf16 v[36:39], v[104:107], v[196:199], v[36:39]
    ds_read_b128 v[248:251], v153 offset:8192
    v_mfma_f32_16x16x32_bf16 v[32:35], v[104:107], v[192:195], v[32:35]
    ds_read_b128 v[252:255], v153 offset:12288
    ds_read_b64_tr_b16 v[56:57], v11 offset:24576
    v_mfma_f32_16x16x32_bf16 v[116:119], v[104:107], v[124:127], v[116:119]
    ds_read_b64_tr_b16 v[58:59], v11 offset:25088
    s_waitcnt lgkmcnt(15)
    s_nop 0
    v_mfma_f32_16x16x32_bf16 v[44:47], v[108:111], v[220:223], v[44:47]
    ds_read_b128 v[64:67], v154 offset:0
    v_mfma_f32_16x16x32_bf16 v[40:43], v[108:111], v[216:219], v[40:43]
    ds_read_b128 v[68:71], v154 offset:4096
    ds_read_b128 v[72:75], v154 offset:8192
    v_mfma_f32_16x16x32_bf16 v[36:39], v[108:111], v[212:215], v[36:39]
    ds_read_b128 v[76:79], v154 offset:12288
    v_mfma_f32_16x16x32_bf16 v[32:35], v[108:111], v[208:211], v[32:35]
    ds_read_b64_tr_b16 v[60:61], v11 offset:28672
    v_mfma_f32_16x16x32_bf16 v[116:119], v[108:111], v[124:127], v[116:119]
    ds_read_b64_tr_b16 v[62:63], v11 offset:29184
    ds_read_b128 v[80:83], v155 offset:0
    s_waitcnt lgkmcnt(15)
    v_dot2c_f32_bf16 v30, v112, v124
    v_dot2c_f32_bf16 v31, v112, v112
    v_dot2c_f32_bf16 v30, v113, v124
    v_dot2c_f32_bf16_e64 v31, v113, v113
    ds_read_b128 v[84:87], v155 offset:4096
    v_dot2c_f32_bf16 v30, v114, v124
    v_dot2c_f32_bf16 v31, v114, v114
    v_dot2c_f32_bf16_e64 v30, v115, v124
    ds_read_b128 v[88:91], v155 offset:8192
    v_dot2c_f32_bf16 v31, v115, v115
    v_dot2c_f32_bf16 v28, v140, v124
    v_dot2c_f32_bf16 v29, v140, v140
    v_dot2c_f32_bf16 v28, v141, v124
    ds_read_b128 v[92:95], v155 offset:12288
    v_dot2c_f32_bf16 v29, v141, v141
    v_dot2c_f32_bf16 v28, v142, v124
    v_dot2c_f32_bf16 v29, v142, v142
    v_dot2c_f32_bf16 v28, v143, v124
    v_dot2c_f32_bf16 v29, v143, v143
    v_dot2c_f32_bf16 v26, v136, v124
    v_dot2c_f32_bf16 v27, v136, v136
    v_dot2c_f32_bf16 v26, v137, v124
    v_dot2c_f32_bf16 v27, v137, v137
    v_dot2c_f32_bf16 v26, v138, v124
    v_dot2c_f32_bf16 v27, v138, v138
    v_dot2c_f32_bf16 v26, v139, v124
    v_dot2c_f32_bf16 v27, v139, v139
    v_dot2c_f32_bf16 v24, v132, v124
    v_dot2c_f32_bf16 v25, v132, v132
    v_dot2c_f32_bf16 v24, v133, v124
    v_dot2c_f32_bf16 v25, v133, v133
    v_dot2c_f32_bf16 v24, v134, v124
    v_dot2c_f32_bf16 v25, v134, v134
    v_dot2c_f32_bf16 v24, v135, v124
    v_dot2c_f32_bf16 v25, v135, v135
    v_dot2c_f32_bf16 v22, v128, v124
    v_dot2c_f32_bf16 v23, v128, v128
    v_dot2c_f32_bf16 v22, v129, v124
    v_dot2c_f32_bf16 v23, v129, v129
    v_dot2c_f32_bf16 v22, v130, v124
    v_dot2c_f32_bf16 v23, v130, v130
    v_dot2c_f32_bf16 v22, v131, v124
    v_dot2c_f32_bf16 v23, v131, v131
    v_add_u32 v152, s42, v120
    v_add_u32 v153, s42, v121
    v_add_u32 v154, s42, v122
    v_add_u32 v155, s42, v123
    s_add_u32 s25, s42, s27
    v_add_u32 v156, s25, v5
    s_barrier
    v_mfma_f32_16x16x32_bf16 v[44:47], v[48:51], v[236:239], v[44:47]
    ds_read_b128 v[128:131], v156 offset:0
    v_mfma_f32_16x16x32_bf16 v[40:43], v[48:51], v[232:235], v[40:43]
    ds_read_b128 v[132:135], v156 offset:1024
    v_mfma_f32_16x16x32_bf16 v[36:39], v[48:51], v[228:231], v[36:39]
    ds_read_b128 v[136:139], v156 offset:2048
    v_mfma_f32_16x16x32_bf16 v[32:35], v[48:51], v[224:227], v[32:35]
    ds_read_b128 v[140:143], v156 offset:3072
    ds_read_b128 v[112:115], v156 offset:4096
    v_mfma_f32_16x16x32_bf16 v[116:119], v[48:51], v[124:127], v[116:119]
    ds_read_b128 v[160:163], v152 offset:0
    s_waitcnt lgkmcnt(15)
    s_nop 0
    v_mfma_f32_16x16x32_bf16 v[44:47], v[52:55], v[252:255], v[44:47]
    ds_read_b128 v[164:167], v152 offset:4096
    v_mfma_f32_16x16x32_bf16 v[40:43], v[52:55], v[248:251], v[40:43]
    ds_read_b128 v[168:171], v152 offset:8192
    ds_read_b128 v[172:175], v152 offset:12288
    v_mfma_f32_16x16x32_bf16 v[36:39], v[52:55], v[244:247], v[36:39]
    ds_read_b128 v[176:179], v153 offset:0
    v_mfma_f32_16x16x32_bf16 v[32:35], v[52:55], v[240:243], v[32:35]
    ds_read_b128 v[180:183], v153 offset:4096
    v_mfma_f32_16x16x32_bf16 v[116:119], v[52:55], v[124:127], v[116:119]
    ds_read_b128 v[184:187], v153 offset:8192
    ds_read_b128 v[188:191], v153 offset:12288
    s_waitcnt lgkmcnt(15)
    s_nop 0
    v_mfma_f32_16x16x32_bf16 v[44:47], v[56:59], v[76:79], v[44:47]
    ds_read_b128 v[192:195], v154 offset:0
    v_mfma_f32_16x16x32_bf16 v[40:43], v[56:59], v[72:75], v[40:43]
    ds_read_b128 v[196:199], v154 offset:4096
    v_mfma_f32_16x16x32_bf16 v[36:39], v[56:59], v[68:71], v[36:39]
    ds_read_b128 v[200:203], v154 offset:8192
    v_mfma_f32_16x16x32_bf16 v[32:35], v[56:59], v[64:67], v[32:35]
    ds_read_b128 v[204:207], v154 offset:12288
    ds_read_b128 v[208:211], v155 offset:0
    v_mfma_f32_16x16x32_bf16 v[116:119], v[56:59], v[124:127], v[116:119]
    ds_read_b128 v[212:215], v155 offset:4096
    s_waitcnt lgkmcnt(15)
    s_nop 0
    v_mfma_f32_16x16x32_bf16 v[44:47], v[60:63], v[92:95], v[44:47]
    ds_read_b128 v[216:219], v155 offset:8192
    v_mfma_f32_16x16x32_bf16 v[40:43], v[60:63], v[88:91], v[40:43]
    ds_read_b128 v[220:223], v155 offset:12288
    v_mfma_f32_16x16x32_bf16 v[36:39], v[60:63], v[84:87], v[36:39]
    v_mfma_f32_16x16x32_bf16 v[32:35], v[60:63], v[80:83], v[32:35]
    v_mfma_f32_16x16x32_bf16 v[116:119], v[60:63], v[124:127], v[116:119]
    s_waitcnt lgkmcnt(15)
    v_dot2c_f32_bf16 v30, v112, v124
    v_dot2c_f32_bf16 v31, v112, v112
    v_dot2c_f32_bf16 v30, v113, v124
    v_dot2c_f32_bf16 v31, v113, v113
    v_dot2c_f32_bf16 v30, v114, v124
    v_dot2c_f32_bf16 v31, v114, v114
    v_dot2c_f32_bf16 v30, v115, v124
    v_dot2c_f32_bf16 v31, v115, v115
    v_dot2c_f32_bf16 v28, v140, v124
    v_dot2c_f32_bf16 v29, v140, v140
    v_dot2c_f32_bf16 v28, v141, v124
    v_dot2c_f32_bf16 v29, v141, v141
    v_dot2c_f32_bf16 v28, v142, v124
    v_dot2c_f32_bf16 v29, v142, v142
    v_dot2c_f32_bf16 v28, v143, v124
    v_dot2c_f32_bf16 v29, v143, v143
    v_dot2c_f32_bf16 v26, v136, v124
    v_dot2c_f32_bf16 v27, v136, v136
    v_dot2c_f32_bf16 v26, v137, v124
    v_dot2c_f32_bf16 v27, v137, v137
    v_dot2c_f32_bf16 v26, v138, v124
    v_dot2c_f32_bf16 v27, v138, v138
    v_dot2c_f32_bf16 v26, v139, v124
    v_dot2c_f32_bf16 v27, v139, v139
    v_dot2c_f32_bf16 v24, v132, v124
    v_dot2c_f32_bf16 v25, v132, v132
    v_dot2c_f32_bf16 v24, v133, v124
    v_dot2c_f32_bf16 v25, v133, v133
    v_dot2c_f32_bf16 v24, v134, v124
    v_dot2c_f32_bf16 v25, v134, v134
    v_dot2c_f32_bf16 v24, v135, v124
    v_dot2c_f32_bf16 v25, v135, v135
    v_dot2c_f32_bf16 v22, v128, v124
    v_dot2c_f32_bf16 v23, v128, v128
    v_dot2c_f32_bf16 v22, v129, v124
    v_dot2c_f32_bf16 v23, v129, v129
    v_dot2c_f32_bf16 v22, v130, v124
    v_dot2c_f32_bf16 v23, v130, v130
    v_dot2c_f32_bf16 v22, v131, v124
    v_dot2c_f32_bf16 v23, v131, v131
    v_add_u32 v152, s44, v120
    v_add_u32 v153, s44, v121
    v_add_u32 v154, s44, v122
    v_add_u32 v155, s44, v123
    s_add_u32 s25, s44, s27
    v_add_u32 v156, s25, v5
    s_barrier
    ds_read_b128 v[128:131], v156 offset:0
    ds_read_b128 v[132:135], v156 offset:1024
    ds_read_b128 v[136:139], v156 offset:2048
    ds_read_b128 v[140:143], v156 offset:3072
    ds_read_b128 v[112:115], v156 offset:4096
    ds_read_b64_tr_b16 v[96:97], v11 offset:32768
    ds_read_b64_tr_b16 v[98:99], v11 offset:33280
    ds_read_b64_tr_b16 v[100:101], v11 offset:36864
    ds_read_b64_tr_b16 v[102:103], v11 offset:37376
    ds_read_b64_tr_b16 v[104:105], v11 offset:40960
    ds_read_b64_tr_b16 v[106:107], v11 offset:41472
    ds_read_b64_tr_b16 v[108:109], v11 offset:45056
    ds_read_b64_tr_b16 v[110:111], v11 offset:45568
    s_waitcnt lgkmcnt(8)
    v_dot2c_f32_bf16 v30, v112, v124
    v_dot2c_f32_bf16 v31, v112, v112
    v_dot2c_f32_bf16 v30, v113, v124
    v_dot2c_f32_bf16 v31, v113, v113
    v_dot2c_f32_bf16 v30, v114, v124
    ds_read_b128 v[224:227], v152 offset:0
    v_dot2c_f32_bf16 v31, v114, v114
    v_dot2c_f32_bf16 v30, v115, v124
    v_dot2c_f32_bf16 v31, v115, v115
    v_dot2c_f32_bf16 v28, v140, v124
    v_dot2c_f32_bf16_e64 v29, v140, v140
    ds_read_b128 v[228:231], v152 offset:4096
    v_dot2c_f32_bf16 v28, v141, v124
    v_dot2c_f32_bf16 v29, v141, v141
    v_dot2c_f32_bf16 v28, v142, v124
    v_dot2c_f32_bf16 v29, v142, v142
    v_dot2c_f32_bf16_e64 v28, v143, v124
    ds_read_b128 v[232:235], v152 offset:8192
    v_dot2c_f32_bf16 v29, v143, v143
    v_dot2c_f32_bf16 v26, v136, v124
    v_dot2c_f32_bf16 v27, v136, v136
    v_dot2c_f32_bf16 v26, v137, v124
    v_dot2c_f32_bf16_e64 v27, v137, v137
    ds_read_b128 v[236:239], v152 offset:12288
    v_dot2c_f32_bf16 v26, v138, v124
    v_dot2c_f32_bf16 v27, v138, v138
    v_dot2c_f32_bf16 v26, v139, v124
    v_dot2c_f32_bf16 v27, v139, v139
    v_dot2c_f32_bf16_e64 v24, v132, v124
    ds_read_b128 v[240:243], v153 offset:0
    v_dot2c_f32_bf16 v25, v132, v132
    v_dot2c_f32_bf16 v24, v133, v124
    v_dot2c_f32_bf16 v25, v133, v133
    v_dot2c_f32_bf16 v24, v134, v124
    v_dot2c_f32_bf16_e64 v25, v134, v134
    ds_read_b128 v[244:247], v153 offset:4096
    v_dot2c_f32_bf16 v24, v135, v124
    v_dot2c_f32_bf16 v25, v135, v135
    v_dot2c_f32_bf16 v22, v128, v124
    v_dot2c_f32_bf16 v23, v128, v128
    v_dot2c_f32_bf16_e64 v22, v129, v124
    ds_read_b128 v[248:251], v153 offset:8192
    v_dot2c_f32_bf16 v23, v129, v129
    v_dot2c_f32_bf16 v22, v130, v124
    v_dot2c_f32_bf16 v23, v130, v130
    v_dot2c_f32_bf16 v22, v131, v124
    v_dot2c_f32_bf16_e64 v23, v131, v131
    ds_read_b128 v[252:255], v153 offset:12288
    s_waitcnt lgkmcnt(14)
    s_nop 0
    v_mfma_f32_16x16x32_bf16 v[44:47], v[96:99], v[172:175], v[44:47]
    v_add_f32_dpp v22, v22, v22 row_ror:8 row_mask:0xf bank_mask:0xf
    v_add_f32_dpp v23, v23, v23 row_ror:8 row_mask:0xf bank_mask:0xf
    v_mfma_f32_16x16x32_bf16 v[40:43], v[96:99], v[168:171], v[40:43]
    ds_read_b128 v[64:67], v154 offset:0
    v_mfma_f32_16x16x32_bf16 v[36:39], v[96:99], v[164:167], v[36:39]
    v_add_f32_dpp v24, v24, v24 row_ror:8 row_mask:0xf bank_mask:0xf
    v_add_f32_dpp v25, v25, v25 row_ror:8 row_mask:0xf bank_mask:0xf
    v_mfma_f32_16x16x32_bf16 v[32:35], v[96:99], v[160:163], v[32:35]
    ds_read_b128 v[68:71], v154 offset:4096
    v_mfma_f32_16x16x32_bf16 v[116:119], v[96:99], v[124:127], v[116:119]
    v_add_f32_dpp v26, v26, v26 row_ror:8 row_mask:0xf bank_mask:0xf
    v_add_f32_dpp v27, v27, v27 row_ror:8 row_mask:0xf bank_mask:0xf
    s_waitcnt lgkmcnt(14)
    s_nop 0
    v_mfma_f32_16x16x32_bf16 v[44:47], v[100:103], v[188:191], v[44:47]
    ds_read_b128 v[72:75], v154 offset:8192
    v_mfma_f32_16x16x32_bf16 v[40:43], v[100:103], v[184:187], v[40:43]
    ds_read_b128 v[76:79], v154 offset:12288
    v_mfma_f32_16x16x32_bf16 v[36:39], v[100:103], v[180:183], v[36:39]
    v_add_f32_dpp v28, v28, v28 row_ror:8 row_mask:0xf bank_mask:0xf
    v_add_f32_dpp v29, v29, v29 row_ror:8 row_mask:0xf bank_mask:0xf
    v_mfma_f32_16x16x32_bf16 v[32:35], v[100:103], v[176:179], v[32:35]
    ds_read_b128 v[80:83], v155 offset:0
    v_mfma_f32_16x16x32_bf16 v[116:119], v[100:103], v[124:127], v[116:119]
    v_add_f32_dpp v30, v30, v30 row_ror:8 row_mask:0xf bank_mask:0xf
    v_add_f32_dpp v31, v31, v31 row_ror:8 row_mask:0xf bank_mask:0xf
    s_waitcnt lgkmcnt(15)
    s_nop 0
    v_mfma_f32_16x16x32_bf16 v[44:47], v[104:107], v[204:207], v[44:47]
    ds_read_b128 v[84:87], v155 offset:4096
    v_mfma_f32_16x16x32_bf16 v[40:43], v[104:107], v[200:203], v[40:43]
    ds_read_b128 v[88:91], v155 offset:8192
    v_mfma_f32_16x16x32_bf16 v[36:39], v[104:107], v[196:199], v[36:39]
    v_add_f32_dpp v22, v22, v22 row_ror:4 row_mask:0xf bank_mask:0xf
    v_add_f32_dpp v23, v23, v23 row_ror:4 row_mask:0xf bank_mask:0xf
    v_mfma_f32_16x16x32_bf16 v[32:35], v[104:107], v[192:195], v[32:35]
    ds_read_b128 v[92:95], v155 offset:12288
    s_barrier
    v_mfma_f32_16x16x32_bf16 v[116:119], v[104:107], v[124:127], v[116:119]
    ds_read_b64_tr_b16 v[48:49], v11 offset:49152
    s_waitcnt lgkmcnt(15)
    v_mfma_f32_16x16x32_bf16 v[44:47], v[108:111], v[220:223], v[44:47]
    ds_read_b64_tr_b16 v[50:51], v11 offset:49664
    ds_read_b64_tr_b16 v[52:53], v11 offset:53248
    v_mfma_f32_16x16x32_bf16 v[40:43], v[108:111], v[216:219], v[40:43]
    ds_read_b64_tr_b16 v[54:55], v11 offset:53760
    v_mfma_f32_16x16x32_bf16 v[36:39], v[108:111], v[212:215], v[36:39]
    ds_read_b64_tr_b16 v[56:57], v11 offset:57344
    ds_read_b64_tr_b16 v[58:59], v11 offset:57856
    v_mfma_f32_16x16x32_bf16 v[32:35], v[108:111], v[208:211], v[32:35]
    ds_read_b64_tr_b16 v[60:61], v11 offset:61440
    v_mfma_f32_16x16x32_bf16 v[116:119], v[108:111], v[124:127], v[116:119]
    ds_read_b64_tr_b16 v[62:63], v11 offset:61952
    s_waitcnt lgkmcnt(6)
    s_nop 0
    v_mfma_f32_16x16x32_bf16 v[44:47], v[48:51], v[236:239], v[44:47]
    v_add_f32_dpp v24, v24, v24 row_ror:4 row_mask:0xf bank_mask:0xf
    v_add_f32_dpp v25, v25, v25 row_ror:4 row_mask:0xf bank_mask:0xf
    v_mfma_f32_16x16x32_bf16 v[40:43], v[48:51], v[232:235], v[40:43]
    v_add_f32_dpp v26, v26, v26 row_ror:4 row_mask:0xf bank_mask:0xf
    v_add_f32_dpp v27, v27, v27 row_ror:4 row_mask:0xf bank_mask:0xf
    v_mfma_f32_16x16x32_bf16 v[36:39], v[48:51], v[228:231], v[36:39]
    v_add_f32_dpp v28, v28, v28 row_ror:4 row_mask:0xf bank_mask:0xf
    v_add_f32_dpp v29, v29, v29 row_ror:4 row_mask:0xf bank_mask:0xf
    v_mfma_f32_16x16x32_bf16 v[32:35], v[48:51], v[224:227], v[32:35]
    v_add_f32_dpp v30, v30, v30 row_ror:4 row_mask:0xf bank_mask:0xf
    v_add_f32_dpp v31, v31, v31 row_ror:4 row_mask:0xf bank_mask:0xf
    v_mfma_f32_16x16x32_bf16 v[116:119], v[48:51], v[124:127], v[116:119]
    v_add_f32_dpp v22, v22, v22 row_ror:2 row_mask:0xf bank_mask:0xf
    v_add_f32_dpp v23, v23, v23 row_ror:2 row_mask:0xf bank_mask:0xf
    s_waitcnt lgkmcnt(4)
    s_nop 0
    v_mfma_f32_16x16x32_bf16 v[44:47], v[52:55], v[252:255], v[44:47]
    v_add_f32_dpp v24, v24, v24 row_ror:2 row_mask:0xf bank_mask:0xf
    v_add_f32_dpp v25, v25, v25 row_ror:2 row_mask:0xf bank_mask:0xf
    v_mfma_f32_16x16x32_bf16 v[40:43], v[52:55], v[248:251], v[40:43]
    v_add_f32_dpp v26, v26, v26 row_ror:2 row_mask:0xf bank_mask:0xf
    v_add_f32_dpp v27, v27, v27 row_ror:2 row_mask:0xf bank_mask:0xf
    v_mfma_f32_16x16x32_bf16 v[36:39], v[52:55], v[244:247], v[36:39]
    v_add_f32_dpp v28, v28, v28 row_ror:2 row_mask:0xf bank_mask:0xf
    v_add_f32_dpp v29, v29, v29 row_ror:2 row_mask:0xf bank_mask:0xf
    v_mfma_f32_16x16x32_bf16 v[32:35], v[52:55], v[240:243], v[32:35]
    v_add_f32_dpp v30, v30, v30 row_ror:2 row_mask:0xf bank_mask:0xf
    v_add_f32_dpp v31, v31, v31 row_ror:2 row_mask:0xf bank_mask:0xf
    v_mfma_f32_16x16x32_bf16 v[116:119], v[52:55], v[124:127], v[116:119]
    v_add_f32_dpp v22, v22, v22 row_ror:1 row_mask:0xf bank_mask:0xf
    v_add_f32_dpp v23, v23, v23 row_ror:1 row_mask:0xf bank_mask:0xf
    s_waitcnt lgkmcnt(2)
    s_nop 0
    v_mfma_f32_16x16x32_bf16 v[44:47], v[56:59], v[76:79], v[44:47]
    v_add_f32_dpp v24, v24, v24 row_ror:1 row_mask:0xf bank_mask:0xf
    v_add_f32_dpp v25, v25, v25 row_ror:1 row_mask:0xf bank_mask:0xf
    v_mfma_f32_16x16x32_bf16 v[40:43], v[56:59], v[72:75], v[40:43]
    v_add_f32_dpp v26, v26, v26 row_ror:1 row_mask:0xf bank_mask:0xf
    v_add_f32_dpp v27, v27, v27 row_ror:1 row_mask:0xf bank_mask:0xf
    v_mfma_f32_16x16x32_bf16 v[36:39], v[56:59], v[68:71], v[36:39]
    v_add_f32_dpp v28, v28, v28 row_ror:1 row_mask:0xf bank_mask:0xf
    v_add_f32_dpp v29, v29, v29 row_ror:1 row_mask:0xf bank_mask:0xf
    v_mfma_f32_16x16x32_bf16 v[32:35], v[56:59], v[64:67], v[32:35]
    v_add_f32_dpp v30, v30, v30 row_ror:1 row_mask:0xf bank_mask:0xf
    v_add_f32_dpp v31, v31, v31 row_ror:1 row_mask:0xf bank_mask:0xf
    v_mfma_f32_16x16x32_bf16 v[116:119], v[56:59], v[124:127], v[116:119]
    v_mov_b32_dpp v22, v24 quad_perm:[0,1,2,3] row_mask:0xf bank_mask:0x2
    v_mov_b32_dpp v23, v25 quad_perm:[0,1,2,3] row_mask:0xf bank_mask:0x2
    s_waitcnt lgkmcnt(0)
    s_nop 0
    v_mfma_f32_16x16x32_bf16 v[44:47], v[60:63], v[92:95], v[44:47]
    v_mov_b32_dpp v22, v26 quad_perm:[0,1,2,3] row_mask:0xf bank_mask:0x4
    v_mov_b32_dpp v23, v27 quad_perm:[0,1,2,3] row_mask:0xf bank_mask:0x4
    v_mfma_f32_16x16x32_bf16 v[40:43], v[60:63], v[88:91], v[40:43]
    v_mov_b32_dpp v22, v28 quad_perm:[0,1,2,3] row_mask:0xf bank_mask:0x8
    v_mov_b32_dpp v23, v29 quad_perm:[0,1,2,3] row_mask:0xf bank_mask:0x8
    v_mfma_f32_16x16x32_bf16 v[36:39], v[60:63], v[84:87], v[36:39]
    v_cndmask_b32 v22, v22, v30, s[38:39]
    v_cndmask_b32 v23, v23, v31, s[38:39]
    v_mfma_f32_16x16x32_bf16 v[32:35], v[60:63], v[80:83], v[32:35]
    v_mul_f32 v128, 0x3b000000, v22
    v_mul_f32 v133, 0x3b000000, v23
    v_mfma_f32_16x16x32_bf16 v[116:119], v[60:63], v[124:127], v[116:119]
    v_fma_f32 v132, -v128, v128, v133
    v_max_f32_e64 v132, 0, v132
    v_add_f32 v133, 0x3727c5ac, v132
    v_rsq_f32 v129, v133
    v_mov_b32 v130, v128
    v_mul_f32_e64 v133, v129, v129
    v_fmaak_f32 v133, v132, v133, 0x3727c5ac
    v_rsq_f32_e64 v133, v133
    ds_write_b64 v157, v[128:129] offset:0
    v_mul_f32_e64 v131, v129, v133
    ds_write_b64 v157, v[130:131] offset:768
    ds_write_b32 v158, v128 offset:1536
    ds_write_b32 v158, v129 offset:1920
    s_waitcnt lgkmcnt(0)
    s_barrier
    ds_read_b64 v[160:161], v159 offset:784
    ds_read_b64 v[162:163], v159 offset:912
    ds_read_b64 v[164:165], v159 offset:1040
    ds_read_b64 v[166:167], v159 offset:1168
    buffer_load_dword v16, v17, s[12:15], s5 offen sc1
    v_mov_b32 v192, s34
    s_waitcnt lgkmcnt(0)
    v_pk_fma_f32 v[32:33], v[116:117], v[160:161], v[32:33] op_sel_hi:[1,0,1] neg_lo:[0,1,0] neg_hi:[0,1,0]
    v_pk_fma_f32 v[34:35], v[118:119], v[160:161], v[34:35] op_sel_hi:[1,0,1] neg_lo:[0,1,0] neg_hi:[0,1,0]
    v_pk_fma_f32 v[36:37], v[116:117], v[162:163], v[36:37] op_sel_hi:[1,0,1] neg_lo:[0,1,0] neg_hi:[0,1,0]
    v_pk_fma_f32 v[38:39], v[118:119], v[162:163], v[38:39] op_sel_hi:[1,0,1] neg_lo:[0,1,0] neg_hi:[0,1,0]
    v_pk_fma_f32 v[40:41], v[116:117], v[164:165], v[40:41] op_sel_hi:[1,0,1] neg_lo:[0,1,0] neg_hi:[0,1,0]
    v_pk_fma_f32 v[42:43], v[118:119], v[164:165], v[42:43] op_sel_hi:[1,0,1] neg_lo:[0,1,0] neg_hi:[0,1,0]
    v_pk_fma_f32 v[44:45], v[116:117], v[166:167], v[44:45] op_sel_hi:[1,0,1] neg_lo:[0,1,0] neg_hi:[0,1,0]
    v_pk_fma_f32 v[46:47], v[118:119], v[166:167], v[46:47] op_sel_hi:[1,0,1] neg_lo:[0,1,0] neg_hi:[0,1,0]
    v_pk_mul_f32 v[32:33], v[160:161], v[32:33] op_sel:[1,0] op_sel_hi:[1,1]
    v_pk_mul_f32 v[34:35], v[160:161], v[34:35] op_sel:[1,0] op_sel_hi:[1,1]
    v_pk_mul_f32 v[36:37], v[162:163], v[36:37] op_sel:[1,0] op_sel_hi:[1,1]
    v_pk_mul_f32 v[38:39], v[162:163], v[38:39] op_sel:[1,0] op_sel_hi:[1,1]
    v_pk_mul_f32 v[40:41], v[164:165], v[40:41] op_sel:[1,0] op_sel_hi:[1,1]
    v_pk_mul_f32 v[42:43], v[164:165], v[42:43] op_sel:[1,0] op_sel_hi:[1,1]
    v_pk_mul_f32 v[44:45], v[166:167], v[44:45] op_sel:[1,0] op_sel_hi:[1,1]
    v_pk_mul_f32 v[46:47], v[166:167], v[46:47] op_sel:[1,0] op_sel_hi:[1,1]
    v_pk_mul_f32 v[176:177], v[32:33], v[32:33]
    v_pk_mul_f32 v[178:179], v[34:35], v[34:35]
    v_pk_mul_f32 v[180:181], v[36:37], v[36:37]
    v_pk_mul_f32 v[182:183], v[38:39], v[38:39]
    v_pk_mul_f32 v[184:185], v[40:41], v[40:41]
    v_pk_mul_f32 v[186:187], v[42:43], v[42:43]
    v_pk_mul_f32 v[188:189], v[44:45], v[44:45]
    v_pk_mul_f32 v[190:191], v[46:47], v[46:47]
    v_pk_fma_f32 v[176:177], s[34:35], v[176:177], v[192:193] op_sel:[1,0,0] op_sel_hi:[1,1,0]
    v_pk_fma_f32 v[178:179], s[34:35], v[178:179], v[192:193] op_sel:[1,0,0] op_sel_hi:[1,1,0]
    v_pk_fma_f32 v[180:181], s[34:35], v[180:181], v[192:193] op_sel:[1,0,0] op_sel_hi:[1,1,0]
    v_pk_fma_f32 v[182:183], s[34:35], v[182:183], v[192:193] op_sel:[1,0,0] op_sel_hi:[1,1,0]
    v_pk_fma_f32 v[184:185], s[34:35], v[184:185], v[192:193] op_sel:[1,0,0] op_sel_hi:[1,1,0]
    v_pk_fma_f32 v[186:187], s[34:35], v[186:187], v[192:193] op_sel:[1,0,0] op_sel_hi:[1,1,0]
    v_pk_fma_f32 v[188:189], s[34:35], v[188:189], v[192:193] op_sel:[1,0,0] op_sel_hi:[1,1,0]
    v_pk_fma_f32 v[190:191], s[34:35], v[190:191], v[192:193] op_sel:[1,0,0] op_sel_hi:[1,1,0]
    v_pk_mul_f32 v[176:177], v[176:177], v[32:33]
    v_pk_mul_f32 v[178:179], v[178:179], v[34:35]
    v_pk_mul_f32 v[180:181], v[180:181], v[36:37]
    v_pk_mul_f32 v[182:183], v[182:183], v[38:39]
    v_pk_mul_f32 v[184:185], v[184:185], v[40:41]
    v_pk_mul_f32 v[186:187], v[186:187], v[42:43]
    v_pk_mul_f32 v[188:189], v[188:189], v[44:45]
    v_pk_mul_f32 v[190:191], v[190:191], v[46:47]
    v_exp_f32 v176, v176
    v_exp_f32 v177, v177
    v_exp_f32 v178, v178
    v_exp_f32 v179, v179
    v_exp_f32 v180, v180
    v_exp_f32 v181, v181
    v_exp_f32 v182, v182
    v_exp_f32 v183, v183
    v_exp_f32 v184, v184
    v_exp_f32 v185, v185
    v_exp_f32 v186, v186
    v_exp_f32 v187, v187
    v_exp_f32 v188, v188
    v_exp_f32 v189, v189
    v_exp_f32 v190, v190
    v_exp_f32 v191, v191
    ds_read_b64_tr_b16 v[244:245], v12 offset:0
    ds_read_b64_tr_b16 v[246:247], v12 offset:512
    ds_read_b64_tr_b16 v[248:249], v12 offset:1024
    ds_read_b64_tr_b16 v[250:251], v12 offset:1536
    ds_read_b64_tr_b16 v[252:253], v12 offset:2048
    ds_read_b64_tr_b16 v[254:255], v12 offset:2560
    ds_read_b128 v[224:227], v148 offset:0
    ds_read_b128 v[228:231], v144 offset:0
    ds_read_b128 v[232:235], v144 offset:4096
    ds_read_b128 v[236:239], v144 offset:8192
    ds_read_b128 v[240:243], v144 offset:12288
    v_pk_add_f32 v[176:177], v[176:177], 1.0 op_sel_hi:[1,0]
    v_pk_add_f32 v[178:179], v[178:179], 1.0 op_sel_hi:[1,0]
    v_pk_add_f32 v[180:181], v[180:181], 1.0 op_sel_hi:[1,0]
    v_pk_add_f32 v[182:183], v[182:183], 1.0 op_sel_hi:[1,0]
    v_pk_add_f32 v[184:185], v[184:185], 1.0 op_sel_hi:[1,0]
    v_pk_add_f32 v[186:187], v[186:187], 1.0 op_sel_hi:[1,0]
    v_pk_add_f32 v[188:189], v[188:189], 1.0 op_sel_hi:[1,0]
    v_pk_add_f32 v[190:191], v[190:191], 1.0 op_sel_hi:[1,0]
    v_rcp_f32 v176, v176
    v_rcp_f32 v177, v177
    v_rcp_f32 v178, v178
    v_rcp_f32 v179, v179
    v_rcp_f32 v180, v180
    v_rcp_f32 v181, v181
    v_rcp_f32 v182, v182
    v_rcp_f32 v183, v183
    v_rcp_f32 v184, v184
    v_rcp_f32 v185, v185
    v_rcp_f32 v186, v186
    v_rcp_f32 v187, v187
    v_rcp_f32 v188, v188
    v_rcp_f32 v189, v189
    v_rcp_f32 v190, v190
    v_rcp_f32 v191, v191
    v_pk_mul_f32 v[176:177], v[176:177], v[32:33]
    v_pk_mul_f32 v[178:179], v[178:179], v[34:35]
    v_pk_mul_f32 v[180:181], v[180:181], v[36:37]
    v_pk_mul_f32 v[182:183], v[182:183], v[38:39]
    v_pk_mul_f32 v[184:185], v[184:185], v[40:41]
    v_pk_mul_f32 v[186:187], v[186:187], v[42:43]
    v_pk_mul_f32 v[188:189], v[188:189], v[44:45]
    v_pk_mul_f32 v[190:191], v[190:191], v[46:47]
    v_cvt_pk_bf16_f32 v168, v176, v177
    v_cvt_pk_bf16_f32 v169, v178, v179
    v_cvt_pk_bf16_f32 v170, v180, v181
    v_cvt_pk_bf16_f32 v171, v182, v183
    v_cvt_pk_bf16_f32 v172, v184, v185
    v_cvt_pk_bf16_f32 v173, v186, v187
    v_cvt_pk_bf16_f32 v174, v188, v189
    v_cvt_pk_bf16_f32 v175, v190, v191
    v_permlane16_swap_b32 v168, v170
    v_permlane16_swap_b32 v169, v171
    v_permlane16_swap_b32 v172, v174
    v_permlane16_swap_b32_e64 v173, v175
    s_add_u32 s25, s16, 0
    buffer_store_dwordx4 v[168:171], v5, s[20:23], s25 offen sc1
    s_add_u32 s25, s16, 32768
    buffer_store_dwordx4 v[172:175], v5, s[20:23], s25 offen sc1
    s_waitcnt lgkmcnt(0)
    s_nop 0
    v_mfma_f32_16x16x32_bf16 v[120:123], v[244:247], v[124:127], 0
    ds_read_b64_tr_b16 v[52:53], v12 offset:12288
    v_mfma_f32_16x16x32_bf16 v[80:83], v[248:251], v[224:227], 0
    ds_read_b64_tr_b16 v[54:55], v12 offset:12800
    ds_read_b64_tr_b16 v[56:57], v12 offset:13312
    v_mfma_f32_16x16x32_bf16 v[100:103], v[224:227], v[252:255], 0
    ds_read_b64_tr_b16 v[58:59], v12 offset:13824
    v_mfma_f32_16x16x32_bf16 v[84:87], v[248:251], v[228:231], 0
    ds_read_b64_tr_b16 v[60:61], v12 offset:14336
    ds_read_b64_tr_b16 v[62:63], v12 offset:14848
    v_mfma_f32_16x16x32_bf16 v[104:107], v[228:231], v[252:255], 0
    ds_read_b128 v[128:131], v149 offset:0
    v_mfma_f32_16x16x32_bf16 v[64:67], v[244:247], v[228:231], 0
    ds_read_b128 v[132:135], v145 offset:0
    ds_read_b128 v[136:139], v145 offset:4096
    v_mfma_f32_16x16x32_bf16 v[88:91], v[248:251], v[232:235], 0
    ds_read_b128 v[140:143], v145 offset:8192
    v_mfma_f32_16x16x32_bf16 v[108:111], v[232:235], v[252:255], 0
    ds_read_b128 v[48:51], v145 offset:12288
    v_mfma_f32_16x16x32_bf16 v[68:71], v[244:247], v[232:235], 0
    v_xor_b32_e64 v8, 0, v18
    ds_read_b64 v[22:23], v8
    v_mfma_f32_16x16x32_bf16 v[92:95], v[248:251], v[236:239], 0
    v_xor_b32_e64 v8, 16, v18
    ds_read_b64 v[24:25], v8
    v_mfma_f32_16x16x32_bf16 v[112:115], v[236:239], v[252:255], 0
    v_xor_b32_e64 v8, 32, v18
    ds_read_b64 v[26:27], v8
    v_mfma_f32_16x16x32_bf16 v[72:75], v[244:247], v[236:239], 0
    v_xor_b32_e64 v8, 48, v18
    ds_read_b64 v[28:29], v8
    v_mfma_f32_16x16x32_bf16 v[96:99], v[248:251], v[240:243], 0
    ds_read_b64 v[18:19], v19 offset:16
    v_mfma_f32_16x16x32_bf16 v[116:119], v[240:243], v[252:255], 0
    v_and_b32 v8, 1, v4
    v_sub_u32 v152, 0, v8
    v_mfma_f32_16x16x32_bf16 v[76:79], v[244:247], v[240:243], 0
    v_lshl_add_u32 v8, v3, 2, v8
    v_sub_u32 v8, v8, v2
    s_waitcnt lgkmcnt(5)
    s_waitcnt lgkmcnt(0)
    s_barrier
    v_mfma_f32_16x16x32_bf16 v[120:123], v[52:55], v[124:127], v[120:123]
    ds_read_b64_tr_b16 v[244:245], v12 offset:24576
    v_mfma_f32_16x16x32_bf16 v[80:83], v[56:59], v[128:131], v[80:83]
    ds_read_b64_tr_b16 v[246:247], v12 offset:25088
    ds_read_b64_tr_b16 v[248:249], v12 offset:25600
    v_mfma_f32_16x16x32_bf16 v[100:103], v[128:131], v[60:63], v[100:103]
    ds_read_b64_tr_b16 v[250:251], v12 offset:26112
    v_mfma_f32_16x16x32_bf16 v[84:87], v[56:59], v[132:135], v[84:87]
    ds_read_b64_tr_b16 v[252:253], v12 offset:26624
    ds_read_b64_tr_b16 v[254:255], v12 offset:27136
    v_mfma_f32_16x16x32_bf16 v[104:107], v[132:135], v[60:63], v[104:107]
    ds_read_b128 v[224:227], v150 offset:0
    v_mfma_f32_16x16x32_bf16 v[64:67], v[52:55], v[132:135], v[64:67]
    ds_read_b128 v[228:231], v146 offset:0
    ds_read_b128 v[232:235], v146 offset:4096
    v_mfma_f32_16x16x32_bf16 v[88:91], v[56:59], v[136:139], v[88:91]
    ds_read_b128 v[236:239], v146 offset:8192
    v_mfma_f32_16x16x32_bf16 v[108:111], v[136:139], v[60:63], v[108:111]
    ds_read_b128 v[240:243], v146 offset:12288
    v_mfma_f32_16x16x32_bf16 v[68:71], v[52:55], v[136:139], v[68:71]
    v_add_u32 v153, -1, v8
    v_ashrrev_i32 v153, 31, v153
    v_mfma_f32_16x16x32_bf16 v[92:95], v[56:59], v[140:143], v[92:95]
    v_mov_b32 v6, 0x1000c0c
    v_mov_b32 v7, 0xc0c0100
    v_mfma_f32_16x16x32_bf16 v[112:115], v[140:143], v[60:63], v[112:115]
    v_bfi_b32 v6, v152, v6, v7
    v_mov_b32 v7, 0x0c0c0c0c
    v_mfma_f32_16x16x32_bf16 v[72:75], v[52:55], v[140:143], v[72:75]
    v_bfi_b32 v155, v153, v6, v7
    v_bfi_b32 v157, v153, v7, v6
    v_mfma_f32_16x16x32_bf16 v[96:99], v[56:59], v[48:51], v[96:99]
    v_add_u32 v154, 1, v8
    v_ashrrev_i32 v154, 31, v154
    v_mfma_f32_16x16x32_bf16 v[116:119], v[48:51], v[60:63], v[116:119]
    v_mov_b32 v6, 0x3020c0c
    v_mov_b32 v7, 0xc0c0302
    v_mfma_f32_16x16x32_bf16 v[76:79], v[52:55], v[48:51], v[76:79]
    v_bfi_b32 v6, v152, v6, v7
    v_mov_b32 v7, 0x0c0c0c0c
    s_waitcnt lgkmcnt(0)
    s_nop 0
    v_mfma_f32_16x16x32_bf16 v[120:123], v[244:247], v[124:127], v[120:123]
    ds_read_b64_tr_b16 v[52:53], v12 offset:36864
    v_mfma_f32_16x16x32_bf16 v[80:83], v[248:251], v[224:227], v[80:83]
    ds_read_b64_tr_b16 v[54:55], v12 offset:37376
    ds_read_b64_tr_b16 v[56:57], v12 offset:37888
    v_mfma_f32_16x16x32_bf16 v[100:103], v[224:227], v[252:255], v[100:103]
    ds_read_b64_tr_b16 v[58:59], v12 offset:38400
    v_mfma_f32_16x16x32_bf16 v[84:87], v[248:251], v[228:231], v[84:87]
    ds_read_b64_tr_b16 v[60:61], v12 offset:38912
    ds_read_b64_tr_b16 v[62:63], v12 offset:39424
    v_mfma_f32_16x16x32_bf16 v[104:107], v[228:231], v[252:255], v[104:107]
    ds_read_b128 v[128:131], v151 offset:0
    v_mfma_f32_16x16x32_bf16 v[64:67], v[244:247], v[228:231], v[64:67]
    ds_read_b128 v[132:135], v147 offset:0
    ds_read_b128 v[136:139], v147 offset:4096
    v_mfma_f32_16x16x32_bf16 v[88:91], v[248:251], v[232:235], v[88:91]
    ds_read_b128 v[140:143], v147 offset:8192
    v_mfma_f32_16x16x32_bf16 v[108:111], v[232:235], v[252:255], v[108:111]
    ds_read_b128 v[48:51], v147 offset:12288
    v_mfma_f32_16x16x32_bf16 v[68:71], v[244:247], v[232:235], v[68:71]
    v_bfi_b32 v156, v154, v6, v7
    v_bfi_b32 v158, v154, v7, v6
    v_mfma_f32_16x16x32_bf16 v[92:95], v[248:251], v[236:239], v[92:95]
    v_mul_f32 v18, v18, v19
    v_lshlrev_b32 v32, 16, v22
    v_mfma_f32_16x16x32_bf16 v[112:115], v[236:239], v[252:255], v[112:115]
    v_and_b32 v33, 0xffff0000, v22
    v_lshlrev_b32_e64 v34, 16, v23
    v_mfma_f32_16x16x32_bf16 v[72:75], v[244:247], v[236:239], v[72:75]
    v_and_b32 v35, 0xffff0000, v23
    v_lshlrev_b32_e64 v36, 16, v24
    v_mfma_f32_16x16x32_bf16 v[96:99], v[248:251], v[240:243], v[96:99]
    v_and_b32 v37, 0xffff0000, v24
    v_lshlrev_b32_e64 v38, 16, v25
    v_mfma_f32_16x16x32_bf16 v[116:119], v[240:243], v[252:255], v[116:119]
    v_and_b32 v39, 0xffff0000, v25
    v_lshlrev_b32_e64 v40, 16, v26
    v_mfma_f32_16x16x32_bf16 v[76:79], v[244:247], v[240:243], v[76:79]
    v_and_b32 v41, 0xffff0000, v26
    v_lshlrev_b32_e64 v42, 16, v27
    s_waitcnt lgkmcnt(0)
    s_barrier
    v_mfma_f32_16x16x32_bf16 v[120:123], v[52:55], v[124:127], v[120:123]
    ds_read_b64_tr_b16 v[244:245], v12 offset:49152
    v_mfma_f32_16x16x32_bf16 v[80:83], v[56:59], v[128:131], v[80:83]
    ds_read_b64_tr_b16 v[246:247], v12 offset:49664
    ds_read_b64_tr_b16 v[248:249], v12 offset:50176
    v_mfma_f32_16x16x32_bf16 v[100:103], v[128:131], v[60:63], v[100:103]
    ds_read_b64_tr_b16 v[250:251], v12 offset:50688
    v_mfma_f32_16x16x32_bf16 v[84:87], v[56:59], v[132:135], v[84:87]
    ds_read_b64_tr_b16 v[252:253], v12 offset:51200
    ds_read_b64_tr_b16 v[254:255], v12 offset:51712
    v_mfma_f32_16x16x32_bf16 v[104:107], v[132:135], v[60:63], v[104:107]
    ds_read_b128 v[224:227], v148 offset:20736
    v_mfma_f32_16x16x32_bf16 v[64:67], v[52:55], v[132:135], v[64:67]
    ds_read_b128 v[228:231], v144 offset:20736
    ds_read_b128 v[232:235], v144 offset:24832
    v_mfma_f32_16x16x32_bf16 v[88:91], v[56:59], v[136:139], v[88:91]
    ds_read_b128 v[236:239], v144 offset:28928
    v_mfma_f32_16x16x32_bf16 v[108:111], v[136:139], v[60:63], v[108:111]
    ds_read_b128 v[240:243], v144 offset:33024
    v_mfma_f32_16x16x32_bf16 v[68:71], v[52:55], v[136:139], v[68:71]
    v_and_b32 v43, 0xffff0000, v27
    v_lshlrev_b32_e64 v44, 16, v28
    v_mfma_f32_16x16x32_bf16 v[92:95], v[56:59], v[140:143], v[92:95]
    v_and_b32 v45, 0xffff0000, v28
    v_lshlrev_b32_e64 v46, 16, v29
    v_mfma_f32_16x16x32_bf16 v[112:115], v[140:143], v[60:63], v[112:115]
    v_and_b32 v47, 0xffff0000, v29
    v_fma_f32 v32, v32, v19, -v18
    v_mfma_f32_16x16x32_bf16 v[72:75], v[52:55], v[140:143], v[72:75]
    v_fma_f32 v33, v33, v19, -v18
    v_fma_f32 v34, v34, v19, -v18
    v_mfma_f32_16x16x32_bf16 v[96:99], v[56:59], v[48:51], v[96:99]
    v_fma_f32 v35, v35, v19, -v18
    v_fma_f32 v36, v36, v19, -v18
    v_mfma_f32_16x16x32_bf16 v[116:119], v[48:51], v[60:63], v[116:119]
    v_fma_f32 v37, v37, v19, -v18
    v_fma_f32 v38, v38, v19, -v18
    v_mfma_f32_16x16x32_bf16 v[76:79], v[52:55], v[48:51], v[76:79]
    v_fma_f32 v39, v39, v19, -v18
    v_fma_f32 v40, v40, v19, -v18
    s_waitcnt lgkmcnt(0)
    s_nop 0
    v_mfma_f32_16x16x32_bf16 v[120:123], v[244:247], v[124:127], v[120:123]
    ds_read_b64_tr_b16 v[52:53], v12 offset:61440
    v_mfma_f32_16x16x32_bf16 v[80:83], v[248:251], v[224:227], v[80:83]
    ds_read_b64_tr_b16 v[54:55], v12 offset:61952
    ds_read_b64_tr_b16 v[56:57], v12 offset:62464
    v_mfma_f32_16x16x32_bf16 v[100:103], v[224:227], v[252:255], v[100:103]
    ds_read_b64_tr_b16 v[58:59], v12 offset:62976
    v_mfma_f32_16x16x32_bf16 v[84:87], v[248:251], v[228:231], v[84:87]
    ds_read_b64_tr_b16 v[60:61], v12 offset:63488
    ds_read_b64_tr_b16 v[62:63], v12 offset:64000
    v_mfma_f32_16x16x32_bf16 v[104:107], v[228:231], v[252:255], v[104:107]
    ds_read_b128 v[128:131], v149 offset:20736
    v_mfma_f32_16x16x32_bf16 v[64:67], v[244:247], v[228:231], v[64:67]
    ds_read_b128 v[132:135], v145 offset:20736
    ds_read_b128 v[136:139], v145 offset:24832
    v_mfma_f32_16x16x32_bf16 v[88:91], v[248:251], v[232:235], v[88:91]
    ds_read_b128 v[140:143], v145 offset:28928
    v_mfma_f32_16x16x32_bf16 v[108:111], v[232:235], v[252:255], v[108:111]
    ds_read_b128 v[48:51], v145 offset:33024
    v_mfma_f32_16x16x32_bf16 v[68:71], v[244:247], v[232:235], v[68:71]
    v_fma_f32 v41, v41, v19, -v18
    v_fma_f32 v42, v42, v19, -v18
    v_mfma_f32_16x16x32_bf16 v[92:95], v[248:251], v[236:239], v[92:95]
    v_fma_f32 v43, v43, v19, -v18
    v_fma_f32 v44, v44, v19, -v18
    v_mfma_f32_16x16x32_bf16 v[112:115], v[236:239], v[252:255], v[112:115]
    v_fma_f32 v45, v45, v19, -v18
    v_fma_f32 v46, v46, v19, -v18
    v_mfma_f32_16x16x32_bf16 v[72:75], v[244:247], v[236:239], v[72:75]
    v_fma_f32 v47, v47, v19, -v18
    v_mfma_f32_16x16x32_bf16 v[96:99], v[248:251], v[240:243], v[96:99]
    v_mfma_f32_16x16x32_bf16 v[116:119], v[240:243], v[252:255], v[116:119]
    v_mfma_f32_16x16x32_bf16 v[76:79], v[244:247], v[240:243], v[76:79]
    s_waitcnt lgkmcnt(0)
    s_barrier
    v_mfma_f32_16x16x32_bf16 v[120:123], v[52:55], v[124:127], v[120:123]
    ds_read_b64_tr_b16 v[244:245], v12 offset:0
    v_mfma_f32_16x16x32_bf16 v[80:83], v[56:59], v[128:131], v[80:83]
    ds_read_b64_tr_b16 v[246:247], v12 offset:512
    ds_read_b64_tr_b16 v[248:249], v12 offset:1024
    v_mfma_f32_16x16x32_bf16 v[100:103], v[128:131], v[60:63], v[100:103]
    ds_read_b64_tr_b16 v[250:251], v12 offset:1536
    v_mfma_f32_16x16x32_bf16 v[84:87], v[56:59], v[132:135], v[84:87]
    ds_read_b64_tr_b16 v[252:253], v12 offset:2048
    ds_read_b64_tr_b16 v[254:255], v12 offset:2560
    v_mfma_f32_16x16x32_bf16 v[104:107], v[132:135], v[60:63], v[104:107]
    ds_read_b128 v[224:227], v150 offset:20736
    v_mfma_f32_16x16x32_bf16 v[64:67], v[52:55], v[132:135], v[64:67]
    ds_read_b128 v[228:231], v146 offset:20736
    ds_read_b128 v[232:235], v146 offset:24832
    v_mfma_f32_16x16x32_bf16 v[88:91], v[56:59], v[136:139], v[88:91]
    ds_read_b128 v[236:239], v146 offset:28928
    v_mfma_f32_16x16x32_bf16 v[108:111], v[136:139], v[60:63], v[108:111]
    ds_read_b128 v[240:243], v146 offset:33024
    v_mfma_f32_16x16x32_bf16 v[68:71], v[52:55], v[136:139], v[68:71]
    v_mfma_f32_16x16x32_bf16 v[92:95], v[56:59], v[140:143], v[92:95]
    v_mfma_f32_16x16x32_bf16 v[112:115], v[140:143], v[60:63], v[112:115]
    v_mfma_f32_16x16x32_bf16 v[72:75], v[52:55], v[140:143], v[72:75]
    v_mfma_f32_16x16x32_bf16 v[96:99], v[56:59], v[48:51], v[96:99]
    v_mfma_f32_16x16x32_bf16 v[116:119], v[48:51], v[60:63], v[116:119]
    v_mfma_f32_16x16x32_bf16 v[76:79], v[52:55], v[48:51], v[76:79]
    s_waitcnt vmcnt(2)
    v_cmp_ne_u32 vcc, s4, v16
    s_mov_b32 s45, 1
    s_cbranch_vccnz ARETRY_1
ADONE_3:
    v_lshlrev_b32_e64 v10, 7, v2
    buffer_load_dword v9, v10, s[20:23], s30 offen sc1
    s_waitcnt vmcnt(1)
    s_cmp_eq_u32 s45, 0
    s_cbranch_scc1 SAFE_4
    buffer_store_dword v15, v14, s[20:23], s55 offen offset:0
STD_5:
    s_waitcnt lgkmcnt(0)
    v_mfma_f32_16x16x32_bf16 v[120:123], v[244:247], v[124:127], v[120:123]
    ds_read_b64_tr_b16 v[52:53], v12 offset:12288
    v_mfma_f32_16x16x32_bf16 v[80:83], v[248:251], v[224:227], v[80:83]
    ds_read_b64_tr_b16 v[54:55], v12 offset:12800
    ds_read_b64_tr_b16 v[56:57], v12 offset:13312
    v_mfma_f32_16x16x32_bf16 v[100:103], v[224:227], v[252:255], v[100:103]
    ds_read_b64_tr_b16 v[58:59], v12 offset:13824
    v_mfma_f32_16x16x32_bf16 v[84:87], v[248:251], v[228:231], v[84:87]
    ds_read_b64_tr_b16 v[60:61], v12 offset:14336
    ds_read_b64_tr_b16 v[62:63], v12 offset:14848
    v_mfma_f32_16x16x32_bf16 v[104:107], v[228:231], v[252:255], v[104:107]
    ds_read_b128 v[128:131], v151 offset:20736
    v_mfma_f32_16x16x32_bf16 v[64:67], v[244:247], v[228:231], v[64:67]
    ds_read_b128 v[132:135], v147 offset:20736
    ds_read_b128 v[136:139], v147 offset:24832
    v_mfma_f32_16x16x32_bf16 v[88:91], v[248:251], v[232:235], v[88:91]
    ds_read_b128 v[140:143], v147 offset:28928
    v_mfma_f32_16x16x32_bf16 v[108:111], v[232:235], v[252:255], v[108:111]
    ds_read_b128 v[48:51], v147 offset:33024
    v_mfma_f32_16x16x32_bf16 v[68:71], v[244:247], v[232:235], v[68:71]
    v_mfma_f32_16x16x32_bf16 v[92:95], v[248:251], v[236:239], v[92:95]
    v_mfma_f32_16x16x32_bf16 v[112:115], v[236:239], v[252:255], v[112:115]
    v_mfma_f32_16x16x32_bf16 v[72:75], v[244:247], v[236:239], v[72:75]
    v_mfma_f32_16x16x32_bf16 v[96:99], v[248:251], v[240:243], v[96:99]
    v_mfma_f32_16x16x32_bf16 v[116:119], v[240:243], v[252:255], v[116:119]
    v_mfma_f32_16x16x32_bf16 v[76:79], v[244:247], v[240:243], v[76:79]
    s_waitcnt lgkmcnt(0)
    s_barrier
    v_mfma_f32_16x16x32_bf16 v[120:123], v[52:55], v[124:127], v[120:123]
    v_add_u32 v144, 41472, v144
    v_mfma_f32_16x16x32_bf16 v[80:83], v[56:59], v[128:131], v[80:83]
    v_add_u32 v145, 41472, v145
    v_add_u32 v146, 41472, v146
    v_mfma_f32_16x16x32_bf16 v[100:103], v[128:131], v[60:63], v[100:103]
    v_add_u32 v147, 41472, v147
    v_mfma_f32_16x16x32_bf16 v[84:87], v[56:59], v[132:135], v[84:87]
    v_add_u32 v148, 41472, v148
    v_add_u32 v149, 41472, v149
    v_mfma_f32_16x16x32_bf16 v[104:107], v[132:135], v[60:63], v[104:107]
    v_add_u32 v150, 41472, v150
    v_mfma_f32_16x16x32_bf16 v[64:67], v[52:55], v[132:135], v[64:67]
    v_add_u32 v151, 41472, v151
    ds_read_b64_tr_b16 v[244:245], v12 offset:24576
    v_mfma_f32_16x16x32_bf16 v[88:91], v[56:59], v[136:139], v[88:91]
    ds_read_b64_tr_b16 v[246:247], v12 offset:25088
    v_mfma_f32_16x16x32_bf16 v[108:111], v[136:139], v[60:63], v[108:111]
    ds_read_b64_tr_b16 v[248:249], v12 offset:25600
    ds_read_b64_tr_b16 v[250:251], v12 offset:26112
    v_mfma_f32_16x16x32_bf16 v[68:71], v[52:55], v[136:139], v[68:71]
    ds_read_b64_tr_b16 v[252:253], v12 offset:26624
    v_mfma_f32_16x16x32_bf16 v[92:95], v[56:59], v[140:143], v[92:95]
    ds_read_b64_tr_b16 v[254:255], v12 offset:27136
    ds_read_b128 v[224:227], v148 offset:0
    v_mfma_f32_16x16x32_bf16 v[112:115], v[140:143], v[60:63], v[112:115]
    ds_read_b128 v[228:231], v144 offset:0
    v_mfma_f32_16x16x32_bf16 v[72:75], v[52:55], v[140:143], v[72:75]
    ds_read_b128 v[232:235], v144 offset:4096
    ds_read_b128 v[236:239], v144 offset:8192
    v_mfma_f32_16x16x32_bf16 v[96:99], v[56:59], v[48:51], v[96:99]
    ds_read_b128 v[240:243], v144 offset:12288
    v_mfma_f32_16x16x32_bf16 v[116:119], v[48:51], v[60:63], v[116:119]
    v_mfma_f32_16x16x32_bf16 v[76:79], v[52:55], v[48:51], v[76:79]
    s_waitcnt lgkmcnt(0)
    s_nop 0
    v_mfma_f32_16x16x32_bf16 v[120:123], v[244:247], v[124:127], v[120:123]
    ds_read_b64_tr_b16 v[52:53], v12 offset:36864
    v_mfma_f32_16x16x32_bf16 v[80:83], v[248:251], v[224:227], v[80:83]
    ds_read_b64_tr_b16 v[54:55], v12 offset:37376
    ds_read_b64_tr_b16 v[56:57], v12 offset:37888
    v_mfma_f32_16x16x32_bf16 v[100:103], v[224:227], v[252:255], v[100:103]
    ds_read_b64_tr_b16 v[58:59], v12 offset:38400
    v_mfma_f32_16x16x32_bf16 v[84:87], v[248:251], v[228:231], v[84:87]
    ds_read_b64_tr_b16 v[60:61], v12 offset:38912
    ds_read_b64_tr_b16 v[62:63], v12 offset:39424
    v_mfma_f32_16x16x32_bf16 v[104:107], v[228:231], v[252:255], v[104:107]
    ds_read_b128 v[128:131], v149 offset:0
    v_mfma_f32_16x16x32_bf16 v[64:67], v[244:247], v[228:231], v[64:67]
    ds_read_b128 v[132:135], v145 offset:0
    ds_read_b128 v[136:139], v145 offset:4096
    v_mfma_f32_16x16x32_bf16 v[88:91], v[248:251], v[232:235], v[88:91]
    ds_read_b128 v[140:143], v145 offset:8192
    v_mfma_f32_16x16x32_bf16 v[108:111], v[232:235], v[252:255], v[108:111]
    ds_read_b128 v[48:51], v145 offset:12288
    v_mfma_f32_16x16x32_bf16 v[68:71], v[244:247], v[232:235], v[68:71]
    v_mfma_f32_16x16x32_bf16 v[92:95], v[248:251], v[236:239], v[92:95]
    v_mfma_f32_16x16x32_bf16 v[112:115], v[236:239], v[252:255], v[112:115]
    v_mfma_f32_16x16x32_bf16 v[72:75], v[244:247], v[236:239], v[72:75]
    v_mfma_f32_16x16x32_bf16 v[96:99], v[248:251], v[240:243], v[96:99]
    v_mfma_f32_16x16x32_bf16 v[116:119], v[240:243], v[252:255], v[116:119]
    v_mfma_f32_16x16x32_bf16 v[76:79], v[244:247], v[240:243], v[76:79]
    s_waitcnt lgkmcnt(0)
    s_barrier
    v_mfma_f32_16x16x32_bf16 v[120:123], v[52:55], v[124:127], v[120:123]
    ds_read_b64_tr_b16 v[244:245], v12 offset:49152
    v_mfma_f32_16x16x32_bf16 v[80:83], v[56:59], v[128:131], v[80:83]
    ds_read_b64_tr_b16 v[246:247], v12 offset:49664
    ds_read_b64_tr_b16 v[248:249], v12 offset:50176
    v_mfma_f32_16x16x32_bf16 v[100:103], v[128:131], v[60:63], v[100:103]
    ds_read_b64_tr_b16 v[250:251], v12 offset:50688
    v_mfma_f32_16x16x32_bf16 v[84:87], v[56:59], v[132:135], v[84:87]
    ds_read_b64_tr_b16 v[252:253], v12 offset:51200
    ds_read_b64_tr_b16 v[254:255], v12 offset:51712
    v_mfma_f32_16x16x32_bf16 v[104:107], v[132:135], v[60:63], v[104:107]
    ds_read_b128 v[224:227], v150 offset:0
    v_mfma_f32_16x16x32_bf16 v[64:67], v[52:55], v[132:135], v[64:67]
    ds_read_b128 v[228:231], v146 offset:0
    ds_read_b128 v[232:235], v146 offset:4096
    v_mfma_f32_16x16x32_bf16 v[88:91], v[56:59], v[136:139], v[88:91]
    ds_read_b128 v[236:239], v146 offset:8192
    v_mfma_f32_16x16x32_bf16 v[108:111], v[136:139], v[60:63], v[108:111]
    ds_read_b128 v[240:243], v146 offset:12288
    v_mfma_f32_16x16x32_bf16 v[68:71], v[52:55], v[136:139], v[68:71]
    v_mfma_f32_16x16x32_bf16 v[92:95], v[56:59], v[140:143], v[92:95]
    v_mfma_f32_16x16x32_bf16 v[112:115], v[140:143], v[60:63], v[112:115]
    v_mfma_f32_16x16x32_bf16 v[72:75], v[52:55], v[140:143], v[72:75]
    v_mfma_f32_16x16x32_bf16 v[96:99], v[56:59], v[48:51], v[96:99]
    v_mfma_f32_16x16x32_bf16 v[116:119], v[48:51], v[60:63], v[116:119]
    v_mfma_f32_16x16x32_bf16 v[76:79], v[52:55], v[48:51], v[76:79]
    s_waitcnt lgkmcnt(0)
    s_nop 0
    v_mfma_f32_16x16x32_bf16 v[120:123], v[244:247], v[124:127], v[120:123]
    ds_read_b64_tr_b16 v[52:53], v12 offset:61440
    v_mfma_f32_16x16x32_bf16 v[80:83], v[248:251], v[224:227], v[80:83]
    ds_read_b64_tr_b16 v[54:55], v12 offset:61952
    ds_read_b64_tr_b16 v[56:57], v12 offset:62464
    v_mfma_f32_16x16x32_bf16 v[100:103], v[224:227], v[252:255], v[100:103]
    ds_read_b64_tr_b16 v[58:59], v12 offset:62976
    v_mfma_f32_16x16x32_bf16 v[84:87], v[248:251], v[228:231], v[84:87]
    ds_read_b64_tr_b16 v[60:61], v12 offset:63488
    ds_read_b64_tr_b16 v[62:63], v12 offset:64000
    v_mfma_f32_16x16x32_bf16 v[104:107], v[228:231], v[252:255], v[104:107]
    ds_read_b128 v[128:131], v151 offset:0
    v_mfma_f32_16x16x32_bf16 v[64:67], v[244:247], v[228:231], v[64:67]
    ds_read_b128 v[132:135], v147 offset:0
    ds_read_b128 v[136:139], v147 offset:4096
    v_mfma_f32_16x16x32_bf16 v[88:91], v[248:251], v[232:235], v[88:91]
    ds_read_b128 v[140:143], v147 offset:8192
    v_mfma_f32_16x16x32_bf16 v[108:111], v[232:235], v[252:255], v[108:111]
    ds_read_b128 v[48:51], v147 offset:12288
    v_mfma_f32_16x16x32_bf16 v[68:71], v[244:247], v[232:235], v[68:71]
    v_mfma_f32_16x16x32_bf16 v[92:95], v[248:251], v[236:239], v[92:95]
    v_mfma_f32_16x16x32_bf16 v[112:115], v[236:239], v[252:255], v[112:115]
    v_mfma_f32_16x16x32_bf16 v[72:75], v[244:247], v[236:239], v[72:75]
    v_mfma_f32_16x16x32_bf16 v[96:99], v[248:251], v[240:243], v[96:99]
    v_mfma_f32_16x16x32_bf16 v[116:119], v[240:243], v[252:255], v[116:119]
    v_mfma_f32_16x16x32_bf16 v[76:79], v[244:247], v[240:243], v[76:79]
    buffer_load_dword v16, v0, s[20:23], s58 offen offset:0 sc1
    s_waitcnt lgkmcnt(0)
    s_barrier
    v_mfma_f32_16x16x32_bf16 v[120:123], v[52:55], v[124:127], v[120:123]
    ds_read_b64_tr_b16 v[244:245], v12 offset:0
    v_mfma_f32_16x16x32_bf16 v[80:83], v[56:59], v[128:131], v[80:83]
    ds_read_b64_tr_b16 v[246:247], v12 offset:512
    ds_read_b64_tr_b16 v[248:249], v12 offset:1024
    v_mfma_f32_16x16x32_bf16 v[100:103], v[128:131], v[60:63], v[100:103]
    ds_read_b64_tr_b16 v[250:251], v12 offset:1536
    v_mfma_f32_16x16x32_bf16 v[84:87], v[56:59], v[132:135], v[84:87]
    ds_read_b64_tr_b16 v[252:253], v12 offset:2048
    ds_read_b64_tr_b16 v[254:255], v12 offset:2560
    v_mfma_f32_16x16x32_bf16 v[104:107], v[132:135], v[60:63], v[104:107]
    ds_read_b128 v[224:227], v148 offset:20736
    v_mfma_f32_16x16x32_bf16 v[64:67], v[52:55], v[132:135], v[64:67]
    ds_read_b128 v[228:231], v144 offset:20736
    ds_read_b128 v[232:235], v144 offset:24832
    v_mfma_f32_16x16x32_bf16 v[88:91], v[56:59], v[136:139], v[88:91]
    ds_read_b128 v[236:239], v144 offset:28928
    v_mfma_f32_16x16x32_bf16 v[108:111], v[136:139], v[60:63], v[108:111]
    ds_read_b128 v[240:243], v144 offset:33024
    v_mfma_f32_16x16x32_bf16 v[68:71], v[52:55], v[136:139], v[68:71]
    v_mfma_f32_16x16x32_bf16 v[92:95], v[56:59], v[140:143], v[92:95]
    v_mfma_f32_16x16x32_bf16 v[112:115], v[140:143], v[60:63], v[112:115]
    v_mfma_f32_16x16x32_bf16 v[72:75], v[52:55], v[140:143], v[72:75]
    v_mfma_f32_16x16x32_bf16 v[96:99], v[56:59], v[48:51], v[96:99]
    v_mfma_f32_16x16x32_bf16 v[116:119], v[48:51], v[60:63], v[116:119]
    v_mfma_f32_16x16x32_bf16 v[76:79], v[52:55], v[48:51], v[76:79]
    s_waitcnt lgkmcnt(0)
    s_nop 0
    v_mfma_f32_16x16x32_bf16 v[120:123], v[244:247], v[124:127], v[120:123]
    ds_read_b64_tr_b16 v[52:53], v12 offset:12288
    v_mfma_f32_16x16x32_bf16 v[80:83], v[248:251], v[224:227], v[80:83]
    ds_read_b64_tr_b16 v[54:55], v12 offset:12800
    ds_read_b64_tr_b16 v[56:57], v12 offset:13312
    v_mfma_f32_16x16x32_bf16 v[100:103], v[224:227], v[252:255], v[100:103]
    ds_read_b64_tr_b16 v[58:59], v12 offset:13824
    v_mfma_f32_16x16x32_bf16 v[84:87], v[248:251], v[228:231], v[84:87]
    ds_read_b64_tr_b16 v[60:61], v12 offset:14336
    ds_read_b64_tr_b16 v[62:63], v12 offset:14848
    v_mfma_f32_16x16x32_bf16 v[104:107], v[228:231], v[252:255], v[104:107]
    ds_read_b128 v[128:131], v149 offset:20736
    v_mfma_f32_16x16x32_bf16 v[64:67], v[244:247], v[228:231], v[64:67]
    ds_read_b128 v[132:135], v145 offset:20736
    ds_read_b128 v[136:139], v145 offset:24832
    v_mfma_f32_16x16x32_bf16 v[88:91], v[248:251], v[232:235], v[88:91]
    ds_read_b128 v[140:143], v145 offset:28928
    v_mfma_f32_16x16x32_bf16 v[108:111], v[232:235], v[252:255], v[108:111]
    ds_read_b128 v[48:51], v145 offset:33024
    v_mfma_f32_16x16x32_bf16 v[68:71], v[244:247], v[232:235], v[68:71]
    v_mfma_f32_16x16x32_bf16 v[92:95], v[248:251], v[236:239], v[92:95]
    v_mfma_f32_16x16x32_bf16 v[112:115], v[236:239], v[252:255], v[112:115]
    v_mfma_f32_16x16x32_bf16 v[72:75], v[244:247], v[236:239], v[72:75]
    v_mfma_f32_16x16x32_bf16 v[96:99], v[248:251], v[240:243], v[96:99]
    v_mfma_f32_16x16x32_bf16 v[116:119], v[240:243], v[252:255], v[116:119]
    v_mfma_f32_16x16x32_bf16 v[76:79], v[244:247], v[240:243], v[76:79]
    s_waitcnt vmcnt(0)
SPIN_6:
    v_cmp_ne_u32 vcc, 1, v16
    s_nop 0
    s_cbranch_vccnz RETRY_7
DONE_8:
    s_waitcnt lgkmcnt(0)
    s_xor_b32 s31, s48, 0
    buffer_load_dwordx4 v[160:163], v5, s[20:23], s31 offen offset:0 sc1
    s_barrier
    s_nop 0
    v_mfma_f32_16x16x32_bf16 v[120:123], v[52:55], v[124:127], v[120:123]
    ds_read_b64_tr_b16 v[244:245], v12 offset:24576
    v_mfma_f32_16x16x32_bf16 v[80:83], v[56:59], v[128:131], v[80:83]
    ds_read_b64_tr_b16 v[246:247], v12 offset:25088
    ds_read_b64_tr_b16 v[248:249], v12 offset:25600
    v_mfma_f32_16x16x32_bf16 v[100:103], v[128:131], v[60:63], v[100:103]
    buffer_load_dwordx4 v[164:167], v5, s[20:23], s31 offen offset:1024 sc1
    ds_read_b64_tr_b16 v[250:251], v12 offset:26112
    v_mfma_f32_16x16x32_bf16 v[84:87], v[56:59], v[132:135], v[84:87]
    ds_read_b64_tr_b16 v[252:253], v12 offset:26624
    ds_read_b64_tr_b16 v[254:255], v12 offset:27136
    v_mfma_f32_16x16x32_bf16 v[104:107], v[132:135], v[60:63], v[104:107]
    ds_read_b128 v[224:227], v150 offset:20736
    v_mfma_f32_16x16x32_bf16 v[64:67], v[52:55], v[132:135], v[64:67]
    buffer_load_dwordx4 v[168:171], v5, s[20:23], s31 offen offset:2048 sc1
    ds_read_b128 v[228:231], v146 offset:20736
    ds_read_b128 v[232:235], v146 offset:24832
    v_mfma_f32_16x16x32_bf16 v[88:91], v[56:59], v[136:139], v[88:91]
    ds_read_b128 v[236:239], v146 offset:28928
    v_mfma_f32_16x16x32_bf16 v[108:111], v[136:139], v[60:63], v[108:111]
    ds_read_b128 v[240:243], v146 offset:33024
    v_mfma_f32_16x16x32_bf16 v[68:71], v[52:55], v[136:139], v[68:71]
    buffer_load_dwordx4 v[172:175], v5, s[20:23], s31 offen offset:3072 sc1
    v_mfma_f32_16x16x32_bf16 v[92:95], v[56:59], v[140:143], v[92:95]
    v_mfma_f32_16x16x32_bf16 v[112:115], v[140:143], v[60:63], v[112:115]
    v_mfma_f32_16x16x32_bf16 v[72:75], v[52:55], v[140:143], v[72:75]
    v_mfma_f32_16x16x32_bf16 v[96:99], v[56:59], v[48:51], v[96:99]
    s_xor_b32 s31, s48, 4096
    buffer_load_dwordx4 v[176:179], v5, s[20:23], s31 offen offset:0 sc1
    v_mfma_f32_16x16x32_bf16 v[116:119], v[48:51], v[60:63], v[116:119]
    v_mfma_f32_16x16x32_bf16 v[76:79], v[52:55], v[48:51], v[76:79]
    s_waitcnt lgkmcnt(0)
    s_nop 0
    v_mfma_f32_16x16x32_bf16 v[120:123], v[244:247], v[124:127], v[120:123]
    ds_read_b64_tr_b16 v[52:53], v12 offset:36864
    v_mfma_f32_16x16x32_bf16 v[80:83], v[248:251], v[224:227], v[80:83]
    buffer_load_dwordx4 v[180:183], v5, s[20:23], s31 offen offset:1024 sc1
    ds_read_b64_tr_b16 v[54:55], v12 offset:37376
    ds_read_b64_tr_b16 v[56:57], v12 offset:37888
    v_mfma_f32_16x16x32_bf16 v[100:103], v[224:227], v[252:255], v[100:103]
    ds_read_b64_tr_b16 v[58:59], v12 offset:38400
    v_mfma_f32_16x16x32_bf16 v[84:87], v[248:251], v[228:231], v[84:87]
    ds_read_b64_tr_b16 v[60:61], v12 offset:38912
    ds_read_b64_tr_b16 v[62:63], v12 offset:39424
    buffer_load_dwordx4 v[184:187], v5, s[20:23], s31 offen offset:2048 sc1
    v_mfma_f32_16x16x32_bf16 v[104:107], v[228:231], v[252:255], v[104:107]
    ds_read_b128 v[128:131], v151 offset:20736
    v_mfma_f32_16x16x32_bf16 v[64:67], v[244:247], v[228:231], v[64:67]
    ds_read_b128 v[132:135], v147 offset:20736
    ds_read_b128 v[136:139], v147 offset:24832
    v_mfma_f32_16x16x32_bf16 v[88:91], v[248:251], v[232:235], v[88:91]
    ds_read_b128 v[140:143], v147 offset:28928
    buffer_load_dwordx4 v[188:191], v5, s[20:23], s31 offen offset:3072 sc1
    v_mfma_f32_16x16x32_bf16 v[108:111], v[232:235], v[252:255], v[108:111]
    ds_read_b128 v[48:51], v147 offset:33024
    v_mfma_f32_16x16x32_bf16 v[68:71], v[244:247], v[232:235], v[68:71]
    v_mfma_f32_16x16x32_bf16 v[92:95], v[248:251], v[236:239], v[92:95]
    v_mfma_f32_16x16x32_bf16 v[112:115], v[236:239], v[252:255], v[112:115]
    s_xor_b32 s31, s48, 8192
    buffer_load_dwordx4 v[192:195], v5, s[20:23], s31 offen offset:0 sc1
    v_mfma_f32_16x16x32_bf16 v[72:75], v[244:247], v[236:239], v[72:75]
    v_mfma_f32_16x16x32_bf16 v[96:99], v[248:251], v[240:243], v[96:99]
    v_mfma_f32_16x16x32_bf16 v[116:119], v[240:243], v[252:255], v[116:119]
    v_mfma_f32_16x16x32_bf16 v[76:79], v[244:247], v[240:243], v[76:79]
    buffer_load_dwordx4 v[196:199], v5, s[20:23], s31 offen offset:1024 sc1
    s_waitcnt lgkmcnt(0)
    s_barrier
    v_mfma_f32_16x16x32_bf16 v[120:123], v[52:55], v[124:127], v[120:123]
    v_add_u32 v18, 8192, v20
    v_mfma_f32_16x16x32_bf16 v[80:83], v[56:59], v[128:131], v[80:83]
    v_add_u32 v19, 8192, v21
    v_mfma_f32_16x16x32_bf16 v[100:103], v[128:131], v[60:63], v[100:103]
    buffer_load_dwordx4 v[200:203], v5, s[20:23], s31 offen offset:2048 sc1
    ds_read_b64_tr_b16 v[224:225], v18 offset:0
    v_mfma_f32_16x16x32_bf16 v[84:87], v[56:59], v[132:135], v[84:87]
    ds_read_b64_tr_b16 v[226:227], v18 offset:512
    ds_read_b64_tr_b16 v[228:229], v19 offset:0
    v_mfma_f32_16x16x32_bf16 v[104:107], v[132:135], v[60:63], v[104:107]
    ds_read_b64_tr_b16 v[230:231], v19 offset:512
    v_mfma_f32_16x16x32_bf16 v[64:67], v[52:55], v[132:135], v[64:67]
    buffer_load_dwordx4 v[204:207], v5, s[20:23], s31 offen offset:3072 sc1
    ds_read_b64_tr_b16 v[232:233], v18 offset:2048
    v_mfma_f32_16x16x32_bf16 v[88:91], v[56:59], v[136:139], v[88:91]
    ds_read_b64_tr_b16 v[234:235], v18 offset:2560
    v_mfma_f32_16x16x32_bf16 v[108:111], v[136:139], v[60:63], v[108:111]
    ds_read_b64_tr_b16 v[236:237], v19 offset:2048
    ds_read_b64_tr_b16 v[238:239], v19 offset:2560
    v_mfma_f32_16x16x32_bf16 v[68:71], v[52:55], v[136:139], v[68:71]
    s_xor_b32 s31, s48, 12288
    buffer_load_dwordx4 v[208:211], v5, s[20:23], s31 offen offset:0 sc1
    ds_read_b64_tr_b16 v[240:241], v18 offset:4096
    v_mfma_f32_16x16x32_bf16 v[92:95], v[56:59], v[140:143], v[92:95]
    ds_read_b64_tr_b16 v[242:243], v18 offset:4608
    v_mfma_f32_16x16x32_bf16 v[112:115], v[140:143], v[60:63], v[112:115]
    ds_read_b64_tr_b16 v[244:245], v19 offset:4096
    v_mfma_f32_16x16x32_bf16 v[72:75], v[52:55], v[140:143], v[72:75]
    ds_read_b64_tr_b16 v[246:247], v19 offset:4608
    buffer_load_dwordx4 v[212:215], v5, s[20:23], s31 offen offset:1024 sc1
    ds_read_b64_tr_b16 v[248:249], v18 offset:6144
    v_mfma_f32_16x16x32_bf16 v[96:99], v[56:59], v[48:51], v[96:99]
    ds_read_b64_tr_b16 v[250:251], v18 offset:6656
    v_mfma_f32_16x16x32_bf16 v[116:119], v[48:51], v[60:63], v[116:119]
    ds_read_b64_tr_b16 v[252:253], v19 offset:6144
    v_mfma_f32_16x16x32_bf16 v[76:79], v[52:55], v[48:51], v[76:79]
    ds_read_b64_tr_b16 v[254:255], v19 offset:6656
    buffer_load_dwordx4 v[216:219], v5, s[20:23], s31 offen offset:2048 sc1
    s_waitcnt lgkmcnt(0)
    s_waitcnt vmcnt(11)
    v_mfma_f32_32x32x16_bf16 v[32:47], v[224:227], v[160:163], v[32:47]
    v_add_u32 v18, 24576, v20
    v_add_u32 v19, 24576, v21
    v_mfma_f32_32x32x16_bf16 v[48:63], v[228:231], v[160:163], 0
    buffer_load_dwordx4 v[220:223], v5, s[20:23], s31 offen offset:3072 sc1
    ds_read_b64_tr_b16 v[128:129], v18 offset:0
    ds_read_b64_tr_b16 v[130:131], v18 offset:512
    ds_read_b64_tr_b16 v[132:133], v19 offset:0
    v_mfma_f32_32x32x16_bf16 v[32:47], v[232:235], v[164:167], v[32:47]
    ds_read_b64_tr_b16 v[134:135], v19 offset:512
    ds_read_b64_tr_b16 v[136:137], v18 offset:2048
    v_mfma_f32_32x32x16_bf16 v[48:63], v[236:239], v[164:167], v[48:63]
    ds_read_b64_tr_b16 v[138:139], v18 offset:2560
    ds_read_b64_tr_b16 v[140:141], v19 offset:2048
    ds_read_b64_tr_b16 v[142:143], v19 offset:2560
    v_mfma_f32_32x32x16_bf16 v[32:47], v[240:243], v[168:171], v[32:47]
    ds_read_b64_tr_b16 v[224:225], v18 offset:4096
    ds_read_b64_tr_b16 v[226:227], v18 offset:4608
    v_mfma_f32_32x32x16_bf16 v[48:63], v[244:247], v[168:171], v[48:63]
    ds_read_b64_tr_b16 v[228:229], v19 offset:4096
    ds_read_b64_tr_b16 v[230:231], v19 offset:4608
    ds_read_b64_tr_b16 v[232:233], v18 offset:6144
    v_mfma_f32_32x32x16_bf16 v[32:47], v[248:251], v[172:175], v[32:47]
    ds_read_b64_tr_b16 v[234:235], v18 offset:6656
    ds_read_b64_tr_b16 v[236:237], v19 offset:6144
    v_mfma_f32_32x32x16_bf16 v[48:63], v[252:255], v[172:175], v[48:63]
    ds_read_b64_tr_b16 v[238:239], v19 offset:6656
    s_waitcnt lgkmcnt(8)
    s_waitcnt vmcnt(8)
    v_mfma_f32_32x32x16_bf16 v[32:47], v[128:131], v[176:179], v[32:47]
    v_add_u32 v18, 40960, v20
    v_add_u32 v19, 40960, v21
    v_mfma_f32_32x32x16_bf16 v[48:63], v[132:135], v[176:179], v[48:63]
    ds_read_b64_tr_b16 v[240:241], v18 offset:0
    ds_read_b64_tr_b16 v[242:243], v18 offset:512
    ds_read_b64_tr_b16 v[244:245], v19 offset:0
    v_mfma_f32_32x32x16_bf16 v[32:47], v[136:139], v[180:183], v[32:47]
    ds_read_b64_tr_b16 v[246:247], v19 offset:512
    ds_read_b64_tr_b16 v[248:249], v18 offset:2048
    v_mfma_f32_32x32x16_bf16 v[48:63], v[140:143], v[180:183], v[48:63]
    ds_read_b64_tr_b16 v[250:251], v18 offset:2560
    ds_read_b64_tr_b16 v[252:253], v19 offset:2048
    ds_read_b64_tr_b16 v[254:255], v19 offset:2560
    s_waitcnt lgkmcnt(8)
    s_nop 0
    v_mfma_f32_32x32x16_bf16 v[32:47], v[224:227], v[184:187], v[32:47]
    ds_read_b64_tr_b16 v[128:129], v18 offset:4096
    ds_read_b64_tr_b16 v[130:131], v18 offset:4608
    v_mfma_f32_32x32x16_bf16 v[48:63], v[228:231], v[184:187], v[48:63]
    ds_read_b64_tr_b16 v[132:133], v19 offset:4096
    ds_read_b64_tr_b16 v[134:135], v19 offset:4608
    ds_read_b64_tr_b16 v[136:137], v18 offset:6144
    v_mfma_f32_32x32x16_bf16 v[32:47], v[232:235], v[188:191], v[32:47]
    ds_read_b64_tr_b16 v[138:139], v18 offset:6656
    ds_read_b64_tr_b16 v[140:141], v19 offset:6144
    v_mfma_f32_32x32x16_bf16 v[48:63], v[236:239], v[188:191], v[48:63]
    ds_read_b64_tr_b16 v[142:143], v19 offset:6656
    s_waitcnt lgkmcnt(8)
    s_waitcnt vmcnt(4)
    v_mfma_f32_32x32x16_bf16 v[32:47], v[240:243], v[192:195], v[32:47]
    v_add_u32 v18, 139264, v20
    v_add_u32 v19, 139264, v21
    v_mfma_f32_32x32x16_bf16 v[48:63], v[244:247], v[192:195], v[48:63]
    ds_read_b64_tr_b16 v[224:225], v18 offset:0
    ds_read_b64_tr_b16 v[226:227], v18 offset:512
    ds_read_b64_tr_b16 v[228:229], v19 offset:0
    v_mfma_f32_32x32x16_bf16 v[32:47], v[248:251], v[196:199], v[32:47]
    ds_read_b64_tr_b16 v[230:231], v19 offset:512
    ds_read_b64_tr_b16 v[232:233], v18 offset:2048
    v_mfma_f32_32x32x16_bf16 v[48:63], v[252:255], v[196:199], v[48:63]
    ds_read_b64_tr_b16 v[234:235], v18 offset:2560
    ds_read_b64_tr_b16 v[236:237], v19 offset:2048
    ds_read_b64_tr_b16 v[238:239], v19 offset:2560
    s_waitcnt lgkmcnt(8)
    s_nop 0
    v_mfma_f32_32x32x16_bf16 v[32:47], v[128:131], v[200:203], v[32:47]
    ds_read_b64_tr_b16 v[240:241], v18 offset:4096
    ds_read_b64_tr_b16 v[242:243], v18 offset:4608
    v_mfma_f32_32x32x16_bf16 v[48:63], v[132:135], v[200:203], v[48:63]
    ds_read_b64_tr_b16 v[244:245], v19 offset:4096
    ds_read_b64_tr_b16 v[246:247], v19 offset:4608
    ds_read_b64_tr_b16 v[248:249], v18 offset:6144
    v_mfma_f32_32x32x16_bf16 v[32:47], v[136:139], v[204:207], v[32:47]
    ds_read_b64_tr_b16 v[250:251], v18 offset:6656
    ds_read_b64_tr_b16 v[252:253], v19 offset:6144
    v_mfma_f32_32x32x16_bf16 v[48:63], v[140:143], v[204:207], v[48:63]
    ds_read_b64_tr_b16 v[254:255], v19 offset:6656
    s_waitcnt lgkmcnt(8)
    s_waitcnt lgkmcnt(0)
    s_barrier
    s_waitcnt vmcnt(0)
    v_mfma_f32_32x32x16_bf16 v[48:63], v[228:231], v[208:211], v[48:63]
    v_mfma_f32_32x32x16_bf16 v[48:63], v[236:239], v[212:215], v[48:63]
    v_mfma_f32_32x32x16_bf16 v[48:63], v[244:247], v[216:219], v[48:63]
    v_mfma_f32_32x32x16_bf16 v[48:63], v[252:255], v[220:223], v[48:63]
    v_mfma_f32_32x32x16_bf16 v[32:47], v[224:227], v[208:211], v[32:47]
    s_add_u32 s25, s32, 8192
    v_add_u32_e64 v6, s25, v5
    s_xor_b32 s25, s32, 8192
    s_add_u32 s25, s25, 8192
    v_add_u32_e64 v7, s25, v5
    v_mfma_f32_32x32x16_bf16 v[32:47], v[232:235], v[212:215], v[32:47]
    v_mfma_f32_32x32x16_bf16 v[32:47], v[240:243], v[216:219], v[32:47]
    s_nop 2
    s_nop 0
    ds_write_b128 v6, v[48:51] offset:0
    ds_write_b128 v6, v[52:55] offset:1024
    v_mfma_f32_32x32x16_bf16 v[32:47], v[248:251], v[220:223], v[32:47]
    ds_write_b128 v6, v[56:59] offset:2048
    ds_write_b128 v6, v[60:63] offset:3072
    s_waitcnt lgkmcnt(0)
    s_barrier
    ds_read_b128 v[48:51], v7 offset:0
    ds_read_b128 v[52:55], v7 offset:1024
    ds_read_b128 v[56:59], v7 offset:2048
    ds_read_b128 v[60:63], v7 offset:3072
    s_waitcnt lgkmcnt(3)
    s_nop 2
    v_pk_add_f32 v[32:33], v[32:33], v[48:49]
    v_pk_add_f32 v[34:35], v[34:35], v[50:51]
    s_waitcnt lgkmcnt(2)
    v_pk_add_f32 v[36:37], v[36:37], v[52:53]
    v_pk_add_f32 v[38:39], v[38:39], v[54:55]
    s_waitcnt lgkmcnt(1)
    v_pk_add_f32 v[40:41], v[40:41], v[56:57]
    v_pk_add_f32 v[42:43], v[42:43], v[58:59]
    s_waitcnt lgkmcnt(0)
    s_nop 0
    v_pk_add_f32 v[44:45], v[44:45], v[60:61]
    v_pk_add_f32 v[46:47], v[46:47], v[62:63]
    v_cvt_pk_bf16_f32 v128, v32, v33
    v_cvt_pk_bf16_f32 v129, v34, v35
    v_cvt_pk_bf16_f32 v130, v36, v37
    v_cvt_pk_bf16_f32 v131, v38, v39
    v_cvt_pk_bf16_f32 v132, v40, v41
    v_cvt_pk_bf16_f32 v133, v42, v43
    v_cvt_pk_bf16_f32 v134, v44, v45
    v_cvt_pk_bf16_f32 v135, v46, v47
    s_lshl_b32 s25, s61, 11
    s_nop 0
    s_add_u32 s25, s25, 4194304
    buffer_store_dwordx4 v[128:131], v5, s[20:23], s25 offen offset:0 sc1
    buffer_store_dwordx4 v[132:135], v5, s[20:23], s25 offen offset:1024 sc1
    v_pk_add_f32 v[48:49], v[32:33], v[34:35]
    v_pk_mul_f32 v[50:51], v[32:33], v[32:33]
    v_pk_fma_f32 v[50:51], v[34:35], v[34:35], v[50:51]
    v_pk_add_f32 v[48:49], v[48:49], v[36:37]
    v_pk_fma_f32 v[50:51], v[36:37], v[36:37], v[50:51]
    v_pk_add_f32 v[48:49], v[48:49], v[38:39]
    v_pk_fma_f32 v[50:51], v[38:39], v[38:39], v[50:51]
    v_pk_add_f32 v[48:49], v[48:49], v[40:41]
    v_pk_fma_f32 v[50:51], v[40:41], v[40:41], v[50:51]
    v_pk_add_f32 v[48:49], v[48:49], v[42:43]
    v_pk_fma_f32 v[50:51], v[42:43], v[42:43], v[50:51]
    v_pk_add_f32 v[48:49], v[48:49], v[44:45]
    v_pk_fma_f32 v[50:51], v[44:45], v[44:45], v[50:51]
    v_pk_add_f32 v[48:49], v[48:49], v[46:47]
    v_pk_fma_f32 v[50:51], v[46:47], v[46:47], v[50:51]
    v_add_f32 v48, v48, v49
    v_add_f32 v50, v50, v51
    v_lshlrev_b32 v6, 2, v4
    s_lshl_b32 s25, s61, 8
    s_add_u32 s25, s25, 13631488
    v_permlane32_swap_b32 v48, v50
    v_add_f32 v48, v48, v50
    buffer_store_dword v48, v6, s[20:23], s25 offen sc1
    v_lshlrev_b32_e64 v7, 4, v3
    ds_read_b128 v[160:163], v7 offset:1536
    ds_read_b128 v[164:167], v7 offset:1920
    ds_read_b128 v[168:171], v7 offset:1600
    ds_read_b128 v[172:175], v7 offset:1984
    ds_read_b128 v[176:179], v7 offset:1664
    ds_read_b128 v[180:183], v7 offset:2048
    ds_read_b128 v[184:187], v7 offset:1728
    ds_read_b128 v[188:191], v7 offset:2112
    ds_read_b128 v[192:195], v7 offset:1792
    ds_read_b128 v[196:199], v7 offset:2176
    v_mov_b32 v148, v100
    v_mov_b32 v149, v100
    v_mov_b32_dpp v144, v80 row_newbcast:0 row_mask:0xf bank_mask:0xf
    v_mov_b32_dpp v145, v81 row_newbcast:0 row_mask:0xf bank_mask:0xf
    v_permlane16_swap_b32 v148, v149
    v_mov_b32 v149, v148
    v_mov_b32_dpp v146, v82 row_newbcast:0 row_mask:0xf bank_mask:0xf
    v_mov_b32_dpp v147, v83 row_newbcast:0 row_mask:0xf bank_mask:0xf
    v_permlane32_swap_b32 v148, v149
    v_lshlrev_b32 v48, 16, v22
    v_and_b32 v49, 0xffff0000, v22
    v_lshlrev_b32_e64 v50, 16, v23
    v_and_b32 v51, 0xffff0000, v23
    v_lshlrev_b32_e64 v52, 16, v24
    v_and_b32 v53, 0xffff0000, v24
    v_lshlrev_b32_e64 v54, 16, v25
    v_and_b32 v55, 0xffff0000, v25
    v_lshlrev_b32_e64 v56, 16, v26
    v_and_b32 v57, 0xffff0000, v26
    v_lshlrev_b32_e64 v58, 16, v27
    v_and_b32 v59, 0xffff0000, v27
    v_lshlrev_b32_e64 v60, 16, v28
    v_and_b32 v61, 0xffff0000, v28
    v_lshlrev_b32_e64 v62, 16, v29
    v_and_b32 v63, 0xffff0000, v29
    v_pk_add_f32 v[32:33], v[32:33], v[48:49]
    v_pk_add_f32 v[34:35], v[34:35], v[50:51]
    v_pk_add_f32 v[36:37], v[36:37], v[52:53]
    v_pk_add_f32 v[38:39], v[38:39], v[54:55]
    v_pk_add_f32 v[40:41], v[40:41], v[56:57]
    v_pk_add_f32 v[42:43], v[42:43], v[58:59]
    v_pk_add_f32 v[44:45], v[44:45], v[60:61]
    v_pk_add_f32 v[46:47], v[46:47], v[62:63]
    v_lshlrev_b32 v6, 3, v2
    s_waitcnt lgkmcnt(0)
    ds_read_b64 v[48:49], v6 offset:0
    ds_read_b64 v[50:51], v6 offset:128
    ds_read_b64 v[52:53], v6 offset:256
    ds_read_b64 v[54:55], v6 offset:384
    ds_read_b64 v[56:57], v6 offset:512
    v_pk_fma_f32 v[100:101], v[160:161], v[148:149], v[100:101] op_sel_hi:[1,0,1] neg_lo:[1,0,0] neg_hi:[1,0,0]
    v_pk_fma_f32 v[102:103], v[162:163], v[148:149], v[102:103] op_sel_hi:[1,0,1] neg_lo:[1,0,0] neg_hi:[1,0,0]
    v_pk_mul_f32 v[100:101], v[100:101], v[164:165]
    v_pk_mul_f32 v[102:103], v[102:103], v[166:167]
    v_pk_fma_f32 v[104:105], v[168:169], v[148:149], v[104:105] op_sel_hi:[1,0,1] neg_lo:[1,0,0] neg_hi:[1,0,0]
    v_pk_fma_f32 v[106:107], v[170:171], v[148:149], v[106:107] op_sel_hi:[1,0,1] neg_lo:[1,0,0] neg_hi:[1,0,0]
    v_pk_mul_f32 v[104:105], v[104:105], v[172:173]
    v_pk_mul_f32 v[106:107], v[106:107], v[174:175]
    v_pk_fma_f32 v[108:109], v[176:177], v[148:149], v[108:109] op_sel_hi:[1,0,1] neg_lo:[1,0,0] neg_hi:[1,0,0]
    v_pk_fma_f32 v[110:111], v[178:179], v[148:149], v[110:111] op_sel_hi:[1,0,1] neg_lo:[1,0,0] neg_hi:[1,0,0]
    v_pk_mul_f32 v[108:109], v[108:109], v[180:181]
    v_pk_mul_f32 v[110:111], v[110:111], v[182:183]
    v_pk_fma_f32 v[112:113], v[184:185], v[148:149], v[112:113] op_sel_hi:[1,0,1] neg_lo:[1,0,0] neg_hi:[1,0,0]
    v_pk_fma_f32 v[114:115], v[186:187], v[148:149], v[114:115] op_sel_hi:[1,0,1] neg_lo:[1,0,0] neg_hi:[1,0,0]
    v_pk_mul_f32 v[112:113], v[112:113], v[188:189]
    v_pk_mul_f32 v[114:115], v[114:115], v[190:191]
    v_pk_fma_f32 v[116:117], v[192:193], v[148:149], v[116:117] op_sel_hi:[1,0,1] neg_lo:[1,0,0] neg_hi:[1,0,0]
    v_pk_fma_f32 v[118:119], v[194:195], v[148:149], v[118:119] op_sel_hi:[1,0,1] neg_lo:[1,0,0] neg_hi:[1,0,0]
    v_pk_mul_f32 v[116:117], v[116:117], v[196:197]
    v_pk_mul_f32 v[118:119], v[118:119], v[198:199]
    s_waitcnt lgkmcnt(0)
    s_nop 0
    v_pk_fma_f32 v[80:81], v[144:145], v[48:49], v[80:81] op_sel_hi:[1,0,1] neg_lo:[0,1,0] neg_hi:[0,1,0]
    v_pk_fma_f32 v[82:83], v[146:147], v[48:49], v[82:83] op_sel_hi:[1,0,1] neg_lo:[0,1,0] neg_hi:[0,1,0]
    v_pk_mul_f32 v[80:81], v[48:49], v[80:81] op_sel:[1,0] op_sel_hi:[1,1]
    v_pk_mul_f32 v[82:83], v[48:49], v[82:83] op_sel:[1,0] op_sel_hi:[1,1]
    v_cvt_pk_bf16_f32 v80, v80, v81
    v_cvt_pk_bf16_f32 v81, v82, v83
    v_pk_fma_f32 v[84:85], v[144:145], v[50:51], v[84:85] op_sel_hi:[1,0,1] neg_lo:[0,1,0] neg_hi:[0,1,0]
    v_pk_fma_f32 v[86:87], v[146:147], v[50:51], v[86:87] op_sel_hi:[1,0,1] neg_lo:[0,1,0] neg_hi:[0,1,0]
    v_pk_mul_f32 v[84:85], v[50:51], v[84:85] op_sel:[1,0] op_sel_hi:[1,1]
    v_pk_mul_f32 v[86:87], v[50:51], v[86:87] op_sel:[1,0] op_sel_hi:[1,1]
    v_cvt_pk_bf16_f32 v84, v84, v85
    v_cvt_pk_bf16_f32 v85, v86, v87
    v_pk_fma_f32 v[88:89], v[144:145], v[52:53], v[88:89] op_sel_hi:[1,0,1] neg_lo:[0,1,0] neg_hi:[0,1,0]
    v_pk_fma_f32 v[90:91], v[146:147], v[52:53], v[90:91] op_sel_hi:[1,0,1] neg_lo:[0,1,0] neg_hi:[0,1,0]
    v_pk_mul_f32 v[88:89], v[52:53], v[88:89] op_sel:[1,0] op_sel_hi:[1,1]
    v_pk_mul_f32 v[90:91], v[52:53], v[90:91] op_sel:[1,0] op_sel_hi:[1,1]
    v_cvt_pk_bf16_f32 v88, v88, v89
    v_cvt_pk_bf16_f32 v89, v90, v91
    v_pk_fma_f32 v[92:93], v[144:145], v[54:55], v[92:93] op_sel_hi:[1,0,1] neg_lo:[0,1,0] neg_hi:[0,1,0]
    v_pk_fma_f32 v[94:95], v[146:147], v[54:55], v[94:95] op_sel_hi:[1,0,1] neg_lo:[0,1,0] neg_hi:[0,1,0]
    v_pk_mul_f32 v[92:93], v[54:55], v[92:93] op_sel:[1,0] op_sel_hi:[1,1]
    v_pk_mul_f32 v[94:95], v[54:55], v[94:95] op_sel:[1,0] op_sel_hi:[1,1]
    v_cvt_pk_bf16_f32 v92, v92, v93
    v_cvt_pk_bf16_f32 v93, v94, v95
    v_pk_fma_f32 v[96:97], v[144:145], v[56:57], v[96:97] op_sel_hi:[1,0,1] neg_lo:[0,1,0] neg_hi:[0,1,0]
    v_pk_fma_f32 v[98:99], v[146:147], v[56:57], v[98:99] op_sel_hi:[1,0,1] neg_lo:[0,1,0] neg_hi:[0,1,0]
    v_pk_mul_f32 v[96:97], v[56:57], v[96:97] op_sel:[1,0] op_sel_hi:[1,1]
    v_pk_mul_f32 v[98:99], v[56:57], v[98:99] op_sel:[1,0] op_sel_hi:[1,1]
    v_cvt_pk_bf16_f32 v96, v96, v97
    v_cvt_pk_bf16_f32 v97, v98, v99
    v_pk_fma_f32 v[64:65], v[120:121], v[50:51], v[64:65] op_sel_hi:[1,0,1] neg_lo:[0,1,0] neg_hi:[0,1,0]
    v_pk_fma_f32 v[66:67], v[122:123], v[50:51], v[66:67] op_sel_hi:[1,0,1] neg_lo:[0,1,0] neg_hi:[0,1,0]
    v_pk_mul_f32 v[64:65], v[50:51], v[64:65] op_sel:[1,0] op_sel_hi:[1,1]
    v_pk_mul_f32 v[66:67], v[50:51], v[66:67] op_sel:[1,0] op_sel_hi:[1,1]
    v_cvt_pk_bf16_f32 v64, v64, v65
    v_cvt_pk_bf16_f32 v65, v66, v67
    v_pk_fma_f32 v[68:69], v[120:121], v[52:53], v[68:69] op_sel_hi:[1,0,1] neg_lo:[0,1,0] neg_hi:[0,1,0]
    v_pk_fma_f32 v[70:71], v[122:123], v[52:53], v[70:71] op_sel_hi:[1,0,1] neg_lo:[0,1,0] neg_hi:[0,1,0]
    v_pk_mul_f32 v[68:69], v[52:53], v[68:69] op_sel:[1,0] op_sel_hi:[1,1]
    v_pk_mul_f32 v[70:71], v[52:53], v[70:71] op_sel:[1,0] op_sel_hi:[1,1]
    v_cvt_pk_bf16_f32 v68, v68, v69
    v_cvt_pk_bf16_f32 v69, v70, v71
    v_pk_fma_f32 v[72:73], v[120:121], v[54:55], v[72:73] op_sel_hi:[1,0,1] neg_lo:[0,1,0] neg_hi:[0,1,0]
    v_pk_fma_f32 v[74:75], v[122:123], v[54:55], v[74:75] op_sel_hi:[1,0,1] neg_lo:[0,1,0] neg_hi:[0,1,0]
    v_pk_mul_f32 v[72:73], v[54:55], v[72:73] op_sel:[1,0] op_sel_hi:[1,1]
    v_pk_mul_f32 v[74:75], v[54:55], v[74:75] op_sel:[1,0] op_sel_hi:[1,1]
    v_cvt_pk_bf16_f32 v72, v72, v73
    v_cvt_pk_bf16_f32 v73, v74, v75
    v_pk_fma_f32 v[76:77], v[120:121], v[56:57], v[76:77] op_sel_hi:[1,0,1] neg_lo:[0,1,0] neg_hi:[0,1,0]
    v_pk_fma_f32 v[78:79], v[122:123], v[56:57], v[78:79] op_sel_hi:[1,0,1] neg_lo:[0,1,0] neg_hi:[0,1,0]
    v_pk_mul_f32 v[76:77], v[56:57], v[76:77] op_sel:[1,0] op_sel_hi:[1,1]
    v_pk_mul_f32 v[78:79], v[56:57], v[78:79] op_sel:[1,0] op_sel_hi:[1,1]
    v_cvt_pk_bf16_f32 v76, v76, v77
    v_cvt_pk_bf16_f32 v77, v78, v79
    v_mfma_f32_16x16x16_bf16 v[48:51], v[84:85], v[64:65], 0
    v_cvt_pk_bf16_f32 v100, v100, v101
    v_cvt_pk_bf16_f32 v101, v102, v103
    v_mfma_f32_16x16x16_bf16 v[128:131], v[80:81], v[64:65], 0
    v_cvt_pk_bf16_f32 v104, v104, v105
    v_cvt_pk_bf16_f32 v105, v106, v107
    v_mfma_f32_16x16x16_bf16 v[52:55], v[88:89], v[68:69], 0
    v_cvt_pk_bf16_f32 v108, v108, v109
    v_cvt_pk_bf16_f32 v109, v110, v111
    v_mfma_f32_16x16x16_bf16 v[132:135], v[84:85], v[68:69], 0
    v_cvt_pk_bf16_f32 v112, v112, v113
    v_cvt_pk_bf16_f32 v113, v114, v115
    v_mfma_f32_16x16x16_bf16 v[56:59], v[92:93], v[72:73], 0
    v_cvt_pk_bf16_f32 v116, v116, v117
    v_cvt_pk_bf16_f32 v117, v118, v119
    v_mfma_f32_16x16x16_bf16 v[136:139], v[88:89], v[72:73], 0
    s_cmp_eq_u32 s3, 0
    s_cselect_b32 s25, -1, 0
    v_mov_b32 v7, 0xcf6e6b28
    v_mfma_f32_16x16x16_bf16 v[60:63], v[96:97], v[76:77], 0
    v_mfma_f32_16x16x16_bf16 v[140:143], v[92:93], v[76:77], 0
    v_bfi_b32 v48, v152, v49, v48
    v_bfi_b32 v128, v152, v129, v128
    v_bfi_b32 v128, s25, v7, v128
    v_bfi_b32 v102, v153, v48, v128
    v_bfi_b32 v50, v152, v51, v50
    v_bfi_b32 v130, v152, v131, v130
    v_bfi_b32 v130, s25, v7, v130
    v_bfi_b32 v103, v154, v50, v130
    v_bfi_b32 v52, v152, v53, v52
    v_bfi_b32 v132, v152, v133, v132
    v_bfi_b32 v106, v153, v52, v132
    v_bfi_b32 v54, v152, v55, v54
    v_bfi_b32 v134, v152, v135, v134
    v_bfi_b32 v107, v154, v54, v134
    v_bfi_b32 v56, v152, v57, v56
    v_bfi_b32 v136, v152, v137, v136
    v_bfi_b32 v110, v153, v56, v136
    v_bfi_b32 v58, v152, v59, v58
    v_bfi_b32 v138, v152, v139, v138
    v_bfi_b32 v111, v154, v58, v138
    v_bfi_b32 v60, v152, v61, v60
    v_bfi_b32 v140, v152, v141, v140
    v_bfi_b32 v114, v153, v60, v140
    v_bfi_b32 v62, v152, v63, v62
    v_bfi_b32 v142, v152, v143, v142
    v_bfi_b32 v115, v154, v62, v142
    v_max_f32 v80, v102, v103
    v_max_f32 v81, v106, v107
    v_max_f32 v82, v110, v111
    v_max_f32 v83, v114, v115
    v_mov_b64 v[84:85], v[80:81]
    v_mov_b64 v[86:87], v[82:83]
    s_nop 0
    v_permlane16_swap_b32 v80, v84
    v_permlane16_swap_b32 v81, v85
    v_permlane16_swap_b32 v82, v86
    v_permlane16_swap_b32 v83, v87
    v_max_f32 v80, v80, v84
    v_max_f32 v81, v81, v85
    v_max_f32 v82, v82, v86
    v_max_f32 v83, v83, v87
    v_mov_b64 v[84:85], v[80:81]
    v_mov_b64 v[86:87], v[82:83]
    s_nop 0
    v_permlane32_swap_b32 v80, v84
    v_permlane32_swap_b32 v81, v85
    v_permlane32_swap_b32 v82, v86
    v_permlane32_swap_b32 v83, v87
    v_max_f32 v80, v80, v84
    v_max_f32 v81, v81, v85
    v_max_f32 v82, v82, v86
    v_max_f32_e64 v83, v83, v87
    s_waitcnt vmcnt(0)
    s_cmp_eq_u32 s45, 0
    s_cbranch_scc1 SAFE_9
    buffer_store_dword v15, v14, s[20:23], s56 offen offset:512
STD_10:
    s_mov_b32 s38, 0x3eb8aa3b
    v_pk_add_f32 v[102:103], v[80:81], v[102:103] op_sel:[0,0] op_sel_hi:[0,1] neg_lo:[1,0] neg_hi:[1,0]
    v_pk_add_f32 v[106:107], v[80:81], v[106:107] op_sel:[1,0] op_sel_hi:[1,1] neg_lo:[1,0] neg_hi:[1,0]
    v_pk_add_f32 v[110:111], v[82:83], v[110:111] op_sel:[0,0] op_sel_hi:[0,1] neg_lo:[1,0] neg_hi:[1,0]
    v_pk_add_f32 v[114:115], v[82:83], v[114:115] op_sel:[1,0] op_sel_hi:[1,1] neg_lo:[1,0] neg_hi:[1,0]
    v_pk_mul_f32 v[102:103], v[102:103], s[38:39] op_sel_hi:[1,0]
    v_pk_mul_f32 v[106:107], v[106:107], s[38:39] op_sel_hi:[1,0]
    v_pk_mul_f32 v[110:111], v[110:111], s[38:39] op_sel_hi:[1,0]
    v_pk_mul_f32 v[114:115], v[114:115], s[38:39] op_sel_hi:[1,0]
    v_exp_f32 v102, v102
    v_exp_f32 v103, v103
    v_exp_f32 v106, v106
    v_exp_f32 v107, v107
    v_exp_f32 v110, v110
    v_exp_f32 v111, v111
    v_exp_f32 v114, v114
    v_exp_f32 v115, v115
    v_cvt_pk_bf16_f32 v102, v102, v103
    v_cvt_pk_bf16_f32 v106, v106, v107
    v_cvt_pk_bf16_f32 v110, v110, v111
    v_cvt_pk_bf16_f32 v114, v114, v115
    v_mov_b32 v103, 0
    v_mov_b32 v107, 0
    v_mov_b32 v111, 0
    v_mov_b32 v115, 0
    v_mfma_f32_16x16x16_bf16 v[48:51], v[124:125], v[102:103], 0
    v_perm_b32 v64, v102, v102, v155
    v_perm_b32 v65, v102, v102, v156
    v_mfma_f32_16x16x16_bf16 v[52:55], v[124:125], v[106:107], 0
    v_perm_b32 v68, v106, v106, v155
    v_perm_b32 v69, v106, v106, v156
    v_mfma_f32_16x16x16_bf16 v[56:59], v[124:125], v[110:111], 0
    v_perm_b32 v72, v110, v110, v155
    v_perm_b32 v73, v110, v110, v156
    v_mfma_f32_16x16x16_bf16 v[60:63], v[124:125], v[114:115], 0
    v_perm_b32 v76, v114, v114, v155
    v_perm_b32 v77, v114, v114, v156
    v_mfma_f32_16x16x16_bf16 v[128:131], v[104:105], v[64:65], 0
    v_perm_b32 v66, v102, v102, v157
    v_perm_b32 v67, v102, v102, v158
    v_mfma_f32_16x16x16_bf16 v[132:135], v[108:109], v[68:69], 0
    v_perm_b32 v70, v106, v106, v157
    v_perm_b32 v71, v106, v106, v158
    v_mfma_f32_16x16x16_bf16 v[136:139], v[112:113], v[72:73], 0
    v_perm_b32 v74, v110, v110, v157
    v_perm_b32 v75, v110, v110, v158
    v_mfma_f32_16x16x16_bf16 v[140:143], v[116:117], v[76:77], 0
    v_perm_b32 v78, v114, v114, v157
    v_perm_b32 v79, v114, v114, v158
    v_mfma_f32_16x16x16_bf16 v[128:131], v[100:101], v[66:67], v[128:131]
    v_rcp_f32_e64 v48, v48
    v_mfma_f32_16x16x16_bf16 v[132:135], v[104:105], v[70:71], v[132:135]
    v_rcp_f32_e64 v52, v52
    v_mfma_f32_16x16x16_bf16 v[136:139], v[108:109], v[74:75], v[136:139]
    v_rcp_f32_e64 v56, v56
    v_mfma_f32_16x16x16_bf16 v[140:143], v[112:113], v[78:79], v[140:143]
    v_rcp_f32 v60, v60
    s_nop 0
    v_pk_mul_f32 v[128:129], v[128:129], v[48:49] op_sel_hi:[1,0]
    v_pk_mul_f32 v[130:131], v[130:131], v[48:49] op_sel_hi:[1,0]
    v_pk_mul_f32 v[132:133], v[132:133], v[52:53] op_sel_hi:[1,0]
    v_pk_mul_f32 v[134:135], v[134:135], v[52:53] op_sel_hi:[1,0]
    v_pk_mul_f32 v[136:137], v[136:137], v[56:57] op_sel_hi:[1,0]
    v_pk_mul_f32 v[138:139], v[138:139], v[56:57] op_sel_hi:[1,0]
    v_pk_mul_f32 v[140:141], v[140:141], v[60:61] op_sel_hi:[1,0]
    v_pk_mul_f32 v[142:143], v[142:143], v[60:61] op_sel_hi:[1,0]
    v_cvt_pk_bf16_f32 v88, v128, v129
    v_cvt_pk_bf16_f32 v89, v130, v131
    v_cvt_pk_bf16_f32 v90, v132, v133
    v_cvt_pk_bf16_f32 v91, v134, v135
    v_cvt_pk_bf16_f32 v92, v136, v137
    v_cvt_pk_bf16_f32 v93, v138, v139
    v_cvt_pk_bf16_f32 v94, v140, v141
    v_cvt_pk_bf16_f32 v95, v142, v143
    v_permlane16_swap_b32 v88, v90
    v_permlane16_swap_b32 v89, v91
    v_permlane16_swap_b32 v92, v94
    v_permlane16_swap_b32 v93, v95
    buffer_load_dword v16, v0, s[20:23], s59 offen offset:512 sc1
    s_add_u32 s25, s16, 2097152
    buffer_store_dwordx4 v[88:91], v5, s[20:23], s25 offen sc1
    s_add_u32 s25, s16, 2129920
    buffer_store_dwordx4 v[92:95], v5, s[20:23], s25 offen sc1
    v_lshrrev_b32_e64 v8, 5, v4
    v_lshl_add_u32 v26, v8, 9, v13
    v_xor_b32 v27, 64, v26
    v_lshlrev_b32 v3, 4, v8
    s_cmp_lt_u32 s7, 14
    s_cselect_b32 s25, 0, 1073741824
    v_add_u32 v2, s25, v5
    v_min_u32_e64 v9, 24, v0
    s_barrier
    s_cmp_ge_u32 s7, 14
    s_cbranch_scc1 L_IDLE0
    v_add_u32 v18, 90112, v26
    v_add_u32 v19, 90112, v27
    v_add_u32 v28, 57344, v26
    v_add_u32 v29, 57344, v27
    ds_read_b64_tr_b16 v[144:145], v18 offset:0
    ds_read_b64_tr_b16 v[146:147], v18 offset:1024
    ds_read_b64_tr_b16 v[148:149], v19 offset:0
    ds_read_b64_tr_b16 v[150:151], v19 offset:1024
    ds_read_b64_tr_b16 v[152:153], v28 offset:0
    ds_read_b64_tr_b16 v[154:155], v28 offset:1024
    ds_read_b64_tr_b16 v[156:157], v29 offset:0
    ds_read_b64_tr_b16 v[158:159], v29 offset:1024
    ds_read_b64_tr_b16 v[128:129], v18 offset:2048
    ds_read_b64_tr_b16 v[130:131], v18 offset:3072
    ds_read_b64_tr_b16 v[132:133], v19 offset:2048
    ds_read_b64_tr_b16 v[134:135], v19 offset:3072
    ds_read_b64_tr_b16 v[136:137], v28 offset:2048
    ds_read_b64_tr_b16 v[138:139], v28 offset:3072
    ds_read_b64_tr_b16 v[140:141], v29 offset:2048
    ds_read_b64_tr_b16 v[142:143], v29 offset:3072
    s_waitcnt vmcnt(2)
SPIN_11:
    v_cmp_ne_u32_e64 vcc, 1, v16
    s_nop 0
    s_cbranch_vccnz RETRY_12
DONE_13:
    s_xor_b32 s31, s49, 0
    buffer_load_dwordx4 v[160:163], v5, s[20:23], s31 offen offset:0 sc1
    buffer_load_dwordx4 v[164:167], v5, s[20:23], s31 offen offset:1024 sc1
    buffer_load_dwordx4 v[168:171], v5, s[20:23], s31 offen offset:2048 sc1
    buffer_load_dwordx4 v[172:175], v5, s[20:23], s31 offen offset:3072 sc1
    s_xor_b32 s31, s49, 4096
    buffer_load_dwordx4 v[176:179], v5, s[20:23], s31 offen offset:0 sc1
    buffer_load_dwordx4 v[180:183], v5, s[20:23], s31 offen offset:1024 sc1
    buffer_load_dwordx4 v[184:187], v5, s[20:23], s31 offen offset:2048 sc1
    buffer_load_dwordx4 v[188:191], v5, s[20:23], s31 offen offset:3072 sc1
    s_waitcnt lgkmcnt(8)
    s_nop 0
    s_xor_b32 s31, s49, 8192
    buffer_load_dwordx4 v[192:195], v5, s[20:23], s31 offen offset:0 sc1
    buffer_load_dwordx4 v[196:199], v5, s[20:23], s31 offen offset:1024 sc1
    buffer_load_dwordx4 v[200:203], v5, s[20:23], s31 offen offset:2048 sc1
    s_waitcnt vmcnt(10)
    s_nop 0
    v_mfma_f32_32x32x16_bf16 v[64:79], v[144:147], v[160:163], 0
    ds_read_b64_tr_b16 v[48:49], v18 offset:4096
    ds_read_b64_tr_b16 v[50:51], v18 offset:5120
    v_mfma_f32_32x32x16_bf16 v[80:95], v[148:151], v[160:163], 0
    ds_read_b64_tr_b16 v[52:53], v19 offset:4096
    buffer_load_dwordx4 v[204:207], v5, s[20:23], s31 offen offset:3072 sc1
    ds_read_b64_tr_b16 v[54:55], v19 offset:5120
    ds_read_b64_tr_b16 v[56:57], v28 offset:4096
    v_mfma_f32_32x32x16_bf16 v[96:111], v[152:155], v[160:163], 0
    ds_read_b64_tr_b16 v[58:59], v28 offset:5120
    ds_read_b64_tr_b16 v[60:61], v29 offset:4096
    v_mfma_f32_32x32x16_bf16 v[112:127], v[156:159], v[160:163], 0
    s_xor_b32 s31, s49, 12288
    buffer_load_dwordx4 v[208:211], v5, s[20:23], s31 offen offset:0 sc1
    ds_read_b64_tr_b16 v[62:63], v29 offset:5120
    s_waitcnt lgkmcnt(8)
    s_waitcnt vmcnt(11)
    v_mfma_f32_32x32x16_bf16 v[64:79], v[128:131], v[164:167], v[64:79]
    ds_read_b64_tr_b16 v[144:145], v18 offset:6144
    ds_read_b64_tr_b16 v[146:147], v18 offset:7168
    v_mfma_f32_32x32x16_bf16 v[80:95], v[132:135], v[164:167], v[80:95]
    buffer_load_dwordx4 v[212:215], v5, s[20:23], s31 offen offset:1024 sc1
    ds_read_b64_tr_b16 v[148:149], v19 offset:6144
    ds_read_b64_tr_b16 v[150:151], v19 offset:7168
    ds_read_b64_tr_b16 v[152:153], v28 offset:6144
    v_mfma_f32_32x32x16_bf16 v[96:111], v[136:139], v[164:167], v[96:111]
    ds_read_b64_tr_b16 v[154:155], v28 offset:7168
    ds_read_b64_tr_b16 v[156:157], v29 offset:6144
    v_mfma_f32_32x32x16_bf16 v[112:127], v[140:143], v[164:167], v[112:127]
    buffer_load_dwordx4 v[216:219], v5, s[20:23], s31 offen offset:2048 sc1
    ds_read_b64_tr_b16 v[158:159], v29 offset:7168
    s_waitcnt lgkmcnt(8)
    s_waitcnt vmcnt(12)
    v_mfma_f32_32x32x16_bf16 v[64:79], v[48:51], v[168:171], v[64:79]
    ds_read_b64_tr_b16 v[128:129], v18 offset:8192
    ds_read_b64_tr_b16 v[130:131], v18 offset:9216
    v_mfma_f32_32x32x16_bf16 v[80:95], v[52:55], v[168:171], v[80:95]
    buffer_load_dwordx4 v[220:223], v5, s[20:23], s31 offen offset:3072 sc1
    ds_read_b64_tr_b16 v[132:133], v19 offset:8192
    ds_read_b64_tr_b16 v[134:135], v19 offset:9216
    ds_read_b64_tr_b16 v[136:137], v28 offset:8192
    v_mfma_f32_32x32x16_bf16 v[96:111], v[56:59], v[168:171], v[96:111]
    ds_read_b64_tr_b16 v[138:139], v28 offset:9216
    ds_read_b64_tr_b16 v[140:141], v29 offset:8192
    v_mfma_f32_32x32x16_bf16 v[112:127], v[60:63], v[168:171], v[112:127]
    s_xor_b32 s31, s49, 16384
    buffer_load_dwordx4 v[224:227], v5, s[20:23], s31 offen offset:0 sc1
    ds_read_b64_tr_b16 v[142:143], v29 offset:9216
    s_waitcnt lgkmcnt(8)
    s_waitcnt vmcnt(13)
    v_mfma_f32_32x32x16_bf16 v[64:79], v[144:147], v[172:175], v[64:79]
    ds_read_b64_tr_b16 v[48:49], v18 offset:10240
    ds_read_b64_tr_b16 v[50:51], v18 offset:11264
    v_mfma_f32_32x32x16_bf16 v[80:95], v[148:151], v[172:175], v[80:95]
    buffer_load_dwordx4 v[228:231], v5, s[20:23], s31 offen offset:1024 sc1
    ds_read_b64_tr_b16 v[52:53], v19 offset:10240
    ds_read_b64_tr_b16 v[54:55], v19 offset:11264
    ds_read_b64_tr_b16 v[56:57], v28 offset:10240
    v_mfma_f32_32x32x16_bf16 v[96:111], v[152:155], v[172:175], v[96:111]
    ds_read_b64_tr_b16 v[58:59], v28 offset:11264
    ds_read_b64_tr_b16 v[60:61], v29 offset:10240
    v_mfma_f32_32x32x16_bf16 v[112:127], v[156:159], v[172:175], v[112:127]
    buffer_load_dwordx4 v[232:235], v5, s[20:23], s31 offen offset:2048 sc1
    ds_read_b64_tr_b16 v[62:63], v29 offset:11264
    s_waitcnt lgkmcnt(8)
    s_waitcnt vmcnt(11)
    v_mfma_f32_32x32x16_bf16 v[64:79], v[128:131], v[176:179], v[64:79]
    ds_read_b64_tr_b16 v[144:145], v18 offset:12288
    ds_read_b64_tr_b16 v[146:147], v18 offset:13312
    v_mfma_f32_32x32x16_bf16 v[80:95], v[132:135], v[176:179], v[80:95]
    buffer_load_dwordx4 v[236:239], v5, s[20:23], s31 offen offset:3072 sc1
    ds_read_b64_tr_b16 v[148:149], v19 offset:12288
    ds_read_b64_tr_b16 v[150:151], v19 offset:13312
    ds_read_b64_tr_b16 v[152:153], v28 offset:12288
    v_mfma_f32_32x32x16_bf16 v[96:111], v[136:139], v[176:179], v[96:111]
    ds_read_b64_tr_b16 v[154:155], v28 offset:13312
    ds_read_b64_tr_b16 v[156:157], v29 offset:12288
    v_mfma_f32_32x32x16_bf16 v[112:127], v[140:143], v[176:179], v[112:127]
    s_xor_b32 s31, s49, 20480
    buffer_load_dwordx4 v[240:243], v5, s[20:23], s31 offen offset:0 sc1
    ds_read_b64_tr_b16 v[158:159], v29 offset:13312
    s_waitcnt lgkmcnt(8)
    s_nop 0
    v_mfma_f32_32x32x16_bf16 v[64:79], v[48:51], v[180:183], v[64:79]
    ds_read_b64_tr_b16 v[128:129], v18 offset:14336
    ds_read_b64_tr_b16 v[130:131], v18 offset:15360
    v_mfma_f32_32x32x16_bf16 v[80:95], v[52:55], v[180:183], v[80:95]
    buffer_load_dwordx4 v[244:247], v5, s[20:23], s31 offen offset:1024 sc1
    ds_read_b64_tr_b16 v[132:133], v19 offset:14336
    ds_read_b64_tr_b16 v[134:135], v19 offset:15360
    ds_read_b64_tr_b16 v[136:137], v28 offset:14336
    v_mfma_f32_32x32x16_bf16 v[96:111], v[56:59], v[180:183], v[96:111]
    ds_read_b64_tr_b16 v[138:139], v28 offset:15360
    ds_read_b64_tr_b16 v[140:141], v29 offset:14336
    v_mfma_f32_32x32x16_bf16 v[112:127], v[60:63], v[180:183], v[112:127]
    buffer_load_dwordx4 v[248:251], v5, s[20:23], s31 offen offset:2048 sc1
    ds_read_b64_tr_b16 v[142:143], v29 offset:15360
    s_waitcnt lgkmcnt(8)
    s_nop 0
    v_mfma_f32_32x32x16_bf16 v[64:79], v[144:147], v[184:187], v[64:79]
    v_add_u32 v18, 73728, v26
    v_add_u32 v19, 73728, v27
    v_mfma_f32_32x32x16_bf16 v[80:95], v[148:151], v[184:187], v[80:95]
    buffer_load_dwordx4 v[252:255], v5, s[20:23], s31 offen offset:3072 sc1
    v_add_u32 v28, 106496, v26
    v_add_u32 v29, 106496, v27
    ds_read_b64_tr_b16 v[48:49], v18 offset:0
    v_mfma_f32_32x32x16_bf16 v[96:111], v[152:155], v[184:187], v[96:111]
    ds_read_b64_tr_b16 v[50:51], v18 offset:1024
    ds_read_b64_tr_b16 v[52:53], v19 offset:0
    v_mfma_f32_32x32x16_bf16 v[112:127], v[156:159], v[184:187], v[112:127]
    s_xor_b32 s31, s49, 24576
    buffer_load_dwordx4 v[160:163], v5, s[20:23], s31 offen offset:0 sc1
    ds_read_b64_tr_b16 v[54:55], v19 offset:1024
    ds_read_b64_tr_b16 v[56:57], v28 offset:0
    ds_read_b64_tr_b16 v[58:59], v28 offset:1024
    ds_read_b64_tr_b16 v[60:61], v29 offset:0
    ds_read_b64_tr_b16 v[62:63], v29 offset:1024
    s_waitcnt lgkmcnt(8)
    s_barrier
    v_mfma_f32_32x32x16_bf16 v[64:79], v[128:131], v[188:191], v[64:79]
    ds_read_b64_tr_b16 v[144:145], v18 offset:2048
    buffer_load_dwordx4 v[164:167], v5, s[20:23], s31 offen offset:1024 sc1
    ds_read_b64_tr_b16 v[146:147], v18 offset:3072
    v_mfma_f32_32x32x16_bf16 v[80:95], v[132:135], v[188:191], v[80:95]
    ds_read_b64_tr_b16 v[148:149], v19 offset:2048
    ds_read_b64_tr_b16 v[150:151], v19 offset:3072
    ds_read_b64_tr_b16 v[152:153], v28 offset:2048
    v_mfma_f32_32x32x16_bf16 v[96:111], v[136:139], v[188:191], v[96:111]
    ds_read_b64_tr_b16 v[154:155], v28 offset:3072
    buffer_load_dwordx4 v[168:171], v5, s[20:23], s31 offen offset:2048 sc1
    ds_read_b64_tr_b16 v[156:157], v29 offset:2048
    v_mfma_f32_32x32x16_bf16 v[112:127], v[140:143], v[188:191], v[112:127]
    ds_read_b64_tr_b16 v[158:159], v29 offset:3072
    s_cmp_eq_u32 s45, 0
    s_cbranch_scc1 SAFE_14
    buffer_store_dword v15, v14, s[20:23], s55 offen offset:256
STD_15:
    s_waitcnt lgkmcnt(8)
    s_waitcnt vmcnt(16)
    v_mfma_f32_32x32x16_bf16 v[64:79], v[48:51], v[192:195], v[64:79]
    ds_read_b64_tr_b16 v[128:129], v18 offset:4096
    ds_read_b64_tr_b16 v[130:131], v18 offset:5120
    v_mfma_f32_32x32x16_bf16 v[80:95], v[52:55], v[192:195], v[80:95]
    buffer_load_dwordx4 v[172:175], v5, s[20:23], s31 offen offset:3072 sc1
    ds_read_b64_tr_b16 v[132:133], v19 offset:4096
    ds_read_b64_tr_b16 v[134:135], v19 offset:5120
    ds_read_b64_tr_b16 v[136:137], v28 offset:4096
    v_mfma_f32_32x32x16_bf16 v[96:111], v[56:59], v[192:195], v[96:111]
    ds_read_b64_tr_b16 v[138:139], v28 offset:5120
    ds_read_b64_tr_b16 v[140:141], v29 offset:4096
    v_mfma_f32_32x32x16_bf16 v[112:127], v[60:63], v[192:195], v[112:127]
    s_xor_b32 s31, s49, 28672
    buffer_load_dwordx4 v[176:179], v5, s[20:23], s31 offen offset:0 sc1
    ds_read_b64_tr_b16 v[142:143], v29 offset:5120
    s_waitcnt lgkmcnt(8)
    s_nop 0
    v_mfma_f32_32x32x16_bf16 v[64:79], v[144:147], v[196:199], v[64:79]
    ds_read_b64_tr_b16 v[48:49], v18 offset:6144
    ds_read_b64_tr_b16 v[50:51], v18 offset:7168
    v_mfma_f32_32x32x16_bf16 v[80:95], v[148:151], v[196:199], v[80:95]
    buffer_load_dwordx4 v[180:183], v5, s[20:23], s31 offen offset:1024 sc1
    ds_read_b64_tr_b16 v[52:53], v19 offset:6144
    ds_read_b64_tr_b16 v[54:55], v19 offset:7168
    ds_read_b64_tr_b16 v[56:57], v28 offset:6144
    v_mfma_f32_32x32x16_bf16 v[96:111], v[152:155], v[196:199], v[96:111]
    ds_read_b64_tr_b16 v[58:59], v28 offset:7168
    ds_read_b64_tr_b16 v[60:61], v29 offset:6144
    v_mfma_f32_32x32x16_bf16 v[112:127], v[156:159], v[196:199], v[112:127]
    buffer_load_dwordx4 v[184:187], v5, s[20:23], s31 offen offset:2048 sc1
    ds_read_b64_tr_b16 v[62:63], v29 offset:7168
    s_waitcnt lgkmcnt(8)
    s_nop 0
    v_mfma_f32_32x32x16_bf16 v[64:79], v[128:131], v[200:203], v[64:79]
    ds_read_b64_tr_b16 v[144:145], v18 offset:8192
    ds_read_b64_tr_b16 v[146:147], v18 offset:9216
    v_mfma_f32_32x32x16_bf16 v[80:95], v[132:135], v[200:203], v[80:95]
    buffer_load_dwordx4 v[188:191], v5, s[20:23], s31 offen offset:3072 sc1
    ds_read_b64_tr_b16 v[148:149], v19 offset:8192
    ds_read_b64_tr_b16 v[150:151], v19 offset:9216
    ds_read_b64_tr_b16 v[152:153], v28 offset:8192
    v_mfma_f32_32x32x16_bf16 v[96:111], v[136:139], v[200:203], v[96:111]
    ds_read_b64_tr_b16 v[154:155], v28 offset:9216
    ds_read_b64_tr_b16 v[156:157], v29 offset:8192
    v_mfma_f32_32x32x16_bf16 v[112:127], v[140:143], v[200:203], v[112:127]
    ds_read_b64_tr_b16 v[158:159], v29 offset:9216
    s_waitcnt lgkmcnt(8)
    s_nop 0
    v_mfma_f32_32x32x16_bf16 v[64:79], v[48:51], v[204:207], v[64:79]
    ds_read_b64_tr_b16 v[128:129], v18 offset:10240
    ds_read_b64_tr_b16 v[130:131], v18 offset:11264
    v_mfma_f32_32x32x16_bf16 v[80:95], v[52:55], v[204:207], v[80:95]
    ds_read_b64_tr_b16 v[132:133], v19 offset:10240
    ds_read_b64_tr_b16 v[134:135], v19 offset:11264
    ds_read_b64_tr_b16 v[136:137], v28 offset:10240
    v_mfma_f32_32x32x16_bf16 v[96:111], v[56:59], v[204:207], v[96:111]
    ds_read_b64_tr_b16 v[138:139], v28 offset:11264
    ds_read_b64_tr_b16 v[140:141], v29 offset:10240
    v_mfma_f32_32x32x16_bf16 v[112:127], v[60:63], v[204:207], v[112:127]
    ds_read_b64_tr_b16 v[142:143], v29 offset:11264
    s_waitcnt lgkmcnt(8)
    s_waitcnt vmcnt(17)
    v_mfma_f32_32x32x16_bf16 v[64:79], v[144:147], v[208:211], v[64:79]
    ds_read_b64_tr_b16 v[48:49], v18 offset:12288
    ds_read_b64_tr_b16 v[50:51], v18 offset:13312
    v_mfma_f32_32x32x16_bf16 v[80:95], v[148:151], v[208:211], v[80:95]
    ds_read_b64_tr_b16 v[52:53], v19 offset:12288
    ds_read_b64_tr_b16 v[54:55], v19 offset:13312
    ds_read_b64_tr_b16 v[56:57], v28 offset:12288
    v_mfma_f32_32x32x16_bf16 v[96:111], v[152:155], v[208:211], v[96:111]
    ds_read_b64_tr_b16 v[58:59], v28 offset:13312
    ds_read_b64_tr_b16 v[60:61], v29 offset:12288
    v_mfma_f32_32x32x16_bf16 v[112:127], v[156:159], v[208:211], v[112:127]
    ds_read_b64_tr_b16 v[62:63], v29 offset:13312
    s_waitcnt lgkmcnt(8)
    s_nop 0
    v_mfma_f32_32x32x16_bf16 v[64:79], v[128:131], v[212:215], v[64:79]
    ds_read_b64_tr_b16 v[144:145], v18 offset:14336
    ds_read_b64_tr_b16 v[146:147], v18 offset:15360
    v_mfma_f32_32x32x16_bf16 v[80:95], v[132:135], v[212:215], v[80:95]
    ds_read_b64_tr_b16 v[148:149], v19 offset:14336
    ds_read_b64_tr_b16 v[150:151], v19 offset:15360
    ds_read_b64_tr_b16 v[152:153], v28 offset:14336
    v_mfma_f32_32x32x16_bf16 v[96:111], v[136:139], v[212:215], v[96:111]
    ds_read_b64_tr_b16 v[154:155], v28 offset:15360
    ds_read_b64_tr_b16 v[156:157], v29 offset:14336
    v_mfma_f32_32x32x16_bf16 v[112:127], v[140:143], v[212:215], v[112:127]
    ds_read_b64_tr_b16 v[158:159], v29 offset:15360
    s_waitcnt lgkmcnt(8)
    s_nop 0
    v_mfma_f32_32x32x16_bf16 v[64:79], v[48:51], v[216:219], v[64:79]
    v_add_u32 v18, 122880, v26
    v_add_u32 v19, 122880, v27
    v_mfma_f32_32x32x16_bf16 v[80:95], v[52:55], v[216:219], v[80:95]
    ds_read_b64_tr_b16 v[128:129], v18 offset:0
    ds_read_b64_tr_b16 v[130:131], v18 offset:1024
    ds_read_b64_tr_b16 v[132:133], v19 offset:0
    v_mfma_f32_32x32x16_bf16 v[96:111], v[56:59], v[216:219], v[96:111]
    ds_read_b64_tr_b16 v[134:135], v19 offset:1024
    ds_read_b64_tr_b16 v[136:137], v18 offset:2048
    v_mfma_f32_32x32x16_bf16 v[112:127], v[60:63], v[216:219], v[112:127]
    ds_read_b64_tr_b16 v[138:139], v18 offset:3072
    ds_read_b64_tr_b16 v[140:141], v19 offset:2048
    ds_read_b64_tr_b16 v[142:143], v19 offset:3072
    s_waitcnt lgkmcnt(8)
    s_barrier
    v_mfma_f32_32x32x16_bf16 v[64:79], v[144:147], v[220:223], v[64:79]
    ds_read_b64_tr_b16 v[48:49], v18 offset:4096
    ds_read_b64_tr_b16 v[50:51], v18 offset:5120
    v_mfma_f32_32x32x16_bf16 v[80:95], v[148:151], v[220:223], v[80:95]
    ds_read_b64_tr_b16 v[52:53], v19 offset:4096
    ds_read_b64_tr_b16 v[54:55], v19 offset:5120
    ds_read_b64_tr_b16 v[56:57], v18 offset:6144
    v_mfma_f32_32x32x16_bf16 v[96:111], v[152:155], v[220:223], v[96:111]
    ds_read_b64_tr_b16 v[58:59], v18 offset:7168
    ds_read_b64_tr_b16 v[60:61], v19 offset:6144
    v_mfma_f32_32x32x16_bf16 v[112:127], v[156:159], v[220:223], v[112:127]
    ds_read_b64_tr_b16 v[62:63], v19 offset:7168
    buffer_load_dword v16, v0, s[20:23], s58 offen offset:256 sc1
    s_waitcnt lgkmcnt(8)
    s_waitcnt vmcnt(14)
    v_mfma_f32_32x32x16_bf16 v[64:79], v[128:131], v[224:227], v[64:79]
    ds_read_b64_tr_b16 v[144:145], v18 offset:8192
    ds_read_b64_tr_b16 v[146:147], v18 offset:9216
    v_mfma_f32_32x32x16_bf16 v[80:95], v[132:135], v[224:227], v[80:95]
    ds_read_b64_tr_b16 v[148:149], v19 offset:8192
    ds_read_b64_tr_b16 v[150:151], v19 offset:9216
    ds_read_b64_tr_b16 v[152:153], v18 offset:10240
    v_mfma_f32_32x32x16_bf16 v[64:79], v[136:139], v[228:231], v[64:79]
    ds_read_b64_tr_b16 v[154:155], v18 offset:11264
    ds_read_b64_tr_b16 v[156:157], v19 offset:10240
    v_mfma_f32_32x32x16_bf16 v[80:95], v[140:143], v[228:231], v[80:95]
    ds_read_b64_tr_b16 v[158:159], v19 offset:11264
    s_waitcnt lgkmcnt(8)
    s_nop 0
    v_mfma_f32_32x32x16_bf16 v[64:79], v[48:51], v[232:235], v[64:79]
    ds_read_b64_tr_b16 v[128:129], v18 offset:12288
    ds_read_b64_tr_b16 v[130:131], v18 offset:13312
    v_mfma_f32_32x32x16_bf16 v[80:95], v[52:55], v[232:235], v[80:95]
    ds_read_b64_tr_b16 v[132:133], v19 offset:12288
    ds_read_b64_tr_b16 v[134:135], v19 offset:13312
    ds_read_b64_tr_b16 v[136:137], v18 offset:14336
    v_mfma_f32_32x32x16_bf16 v[64:79], v[56:59], v[236:239], v[64:79]
    ds_read_b64_tr_b16 v[138:139], v18 offset:15360
    ds_read_b64_tr_b16 v[140:141], v19 offset:14336
    v_mfma_f32_32x32x16_bf16 v[80:95], v[60:63], v[236:239], v[80:95]
    ds_read_b64_tr_b16 v[142:143], v19 offset:15360
    s_waitcnt vmcnt(0)
SPIN_16:
    v_cmp_ne_u32_e64 vcc, 1, v16
    s_nop 0
    s_cbranch_vccnz RETRY_17
DONE_18:
    s_waitcnt lgkmcnt(8)
    v_mfma_f32_32x32x16_bf16 v[64:79], v[144:147], v[240:243], v[64:79]
    v_add_u32 v18, 24576, v26
    v_add_u32 v19, 24576, v27
    v_mfma_f32_32x32x16_bf16 v[80:95], v[148:151], v[240:243], v[80:95]
    ds_read_b64_tr_b16 v[48:49], v18 offset:0
    ds_read_b64_tr_b16 v[50:51], v18 offset:1024
    ds_read_b64_tr_b16 v[52:53], v19 offset:0
    v_mfma_f32_32x32x16_bf16 v[64:79], v[152:155], v[244:247], v[64:79]
    s_xor_b32 s31, s48, 2097152
    buffer_load_dwordx4 v[192:195], v5, s[20:23], s31 offen offset:0 sc1
    ds_read_b64_tr_b16 v[54:55], v19 offset:1024
    ds_read_b64_tr_b16 v[56:57], v18 offset:2048
    v_mfma_f32_32x32x16_bf16 v[80:95], v[156:159], v[244:247], v[80:95]
    ds_read_b64_tr_b16 v[58:59], v18 offset:3072
    ds_read_b64_tr_b16 v[60:61], v19 offset:2048
    ds_read_b64_tr_b16 v[62:63], v19 offset:3072
    s_waitcnt lgkmcnt(8)
    s_barrier
    v_mfma_f32_32x32x16_bf16 v[64:79], v[128:131], v[248:251], v[64:79]
    buffer_load_dwordx4 v[196:199], v5, s[20:23], s31 offen offset:1024 sc1
    ds_read_b64_tr_b16 v[144:145], v18 offset:4096
    ds_read_b64_tr_b16 v[146:147], v18 offset:5120
    v_mfma_f32_32x32x16_bf16 v[80:95], v[132:135], v[248:251], v[80:95]
    ds_read_b64_tr_b16 v[148:149], v19 offset:4096
    ds_read_b64_tr_b16 v[150:151], v19 offset:5120
    ds_read_b64_tr_b16 v[152:153], v18 offset:6144
    v_mfma_f32_32x32x16_bf16 v[64:79], v[136:139], v[252:255], v[64:79]
    buffer_load_dwordx4 v[200:203], v5, s[20:23], s31 offen offset:2048 sc1
    ds_read_b64_tr_b16 v[154:155], v18 offset:7168
    ds_read_b64_tr_b16 v[156:157], v19 offset:6144
    v_mfma_f32_32x32x16_bf16 v[80:95], v[140:143], v[252:255], v[80:95]
    ds_read_b64_tr_b16 v[158:159], v19 offset:7168
    s_waitcnt lgkmcnt(8)
    s_nop 0
    v_mfma_f32_32x32x16_bf16 v[64:79], v[48:51], v[160:163], v[64:79]
    buffer_load_dwordx4 v[204:207], v5, s[20:23], s31 offen offset:3072 sc1
    ds_read_b64_tr_b16 v[128:129], v18 offset:8192
    ds_read_b64_tr_b16 v[130:131], v18 offset:9216
    v_mfma_f32_32x32x16_bf16 v[80:95], v[52:55], v[160:163], v[80:95]
    ds_read_b64_tr_b16 v[132:133], v19 offset:8192
    ds_read_b64_tr_b16 v[134:135], v19 offset:9216
    ds_read_b64_tr_b16 v[136:137], v18 offset:10240
    v_mfma_f32_32x32x16_bf16 v[64:79], v[56:59], v[164:167], v[64:79]
    s_xor_b32 s31, s48, 2101248
    buffer_load_dwordx4 v[208:211], v5, s[20:23], s31 offen offset:0 sc1
    ds_read_b64_tr_b16 v[138:139], v18 offset:11264
    ds_read_b64_tr_b16 v[140:141], v19 offset:10240
    v_mfma_f32_32x32x16_bf16 v[80:95], v[60:63], v[164:167], v[80:95]
    ds_read_b64_tr_b16 v[142:143], v19 offset:11264
    s_waitcnt lgkmcnt(8)
    s_nop 0
    v_mfma_f32_32x32x16_bf16 v[64:79], v[144:147], v[168:171], v[64:79]
    buffer_load_dwordx4 v[212:215], v5, s[20:23], s31 offen offset:1024 sc1
    ds_read_b64_tr_b16 v[48:49], v18 offset:12288
    ds_read_b64_tr_b16 v[50:51], v18 offset:13312
    v_mfma_f32_32x32x16_bf16 v[80:95], v[148:151], v[168:171], v[80:95]
    ds_read_b64_tr_b16 v[52:53], v19 offset:12288
    ds_read_b64_tr_b16 v[54:55], v19 offset:13312
    ds_read_b64_tr_b16 v[56:57], v18 offset:14336
    v_mfma_f32_32x32x16_bf16 v[64:79], v[152:155], v[172:175], v[64:79]
    buffer_load_dwordx4 v[216:219], v5, s[20:23], s31 offen offset:2048 sc1
    ds_read_b64_tr_b16 v[58:59], v18 offset:15360
    ds_read_b64_tr_b16 v[60:61], v19 offset:14336
    v_mfma_f32_32x32x16_bf16 v[80:95], v[156:159], v[172:175], v[80:95]
    ds_read_b64_tr_b16 v[62:63], v19 offset:15360
    s_waitcnt lgkmcnt(8)
    s_nop 0
    ds_read_b128 v[144:147], v3 offset:7424
    ds_read_b128 v[148:151], v3 offset:7456
    ds_read_b128 v[152:155], v3 offset:7488
    buffer_load_dwordx4 v[220:223], v5, s[20:23], s31 offen offset:3072 sc1
    ds_read_b128 v[156:159], v3 offset:7520
    s_lshl_b32 s26, s43, 10
    s_addk_i32 s26, 3328
    v_add_u32_e64 v6, s26, v5
    ds_read_b128 v[22:25], v6
    v_mfma_f32_32x32x16_bf16 v[64:79], v[128:131], v[176:179], v[64:79]
    v_mfma_f32_32x32x16_bf16 v[80:95], v[132:135], v[176:179], v[80:95]
    v_mfma_f32_32x32x16_bf16 v[64:79], v[136:139], v[180:183], v[64:79]
    v_mfma_f32_32x32x16_bf16 v[80:95], v[140:143], v[180:183], v[80:95]
    s_waitcnt lgkmcnt(5)
    s_barrier
    v_mfma_f32_32x32x16_bf16 v[64:79], v[48:51], v[184:187], v[64:79]
    v_mfma_f32_32x32x16_bf16 v[80:95], v[52:55], v[184:187], v[80:95]
    v_mfma_f32_32x32x16_bf16 v[64:79], v[56:59], v[188:191], v[64:79]
    v_mfma_f32_32x32x16_bf16 v[80:95], v[60:63], v[188:191], v[80:95]
    s_waitcnt lgkmcnt(0)
    s_nop 9
    v_pk_fma_f32 v[64:65], v[144:145], v[22:23], v[64:65] op_sel_hi:[1,0,1] neg_lo:[0,1,0] neg_hi:[0,1,0]
    v_pk_fma_f32 v[66:67], v[146:147], v[22:23], v[66:67] op_sel_hi:[1,0,1] neg_lo:[0,1,0] neg_hi:[0,1,0]
    v_pk_fma_f32 v[68:69], v[148:149], v[22:23], v[68:69] op_sel_hi:[1,0,1] neg_lo:[0,1,0] neg_hi:[0,1,0]
    v_pk_fma_f32 v[70:71], v[150:151], v[22:23], v[70:71] op_sel_hi:[1,0,1] neg_lo:[0,1,0] neg_hi:[0,1,0]
    v_pk_fma_f32 v[72:73], v[152:153], v[22:23], v[72:73] op_sel_hi:[1,0,1] neg_lo:[0,1,0] neg_hi:[0,1,0]
    v_pk_fma_f32 v[74:75], v[154:155], v[22:23], v[74:75] op_sel_hi:[1,0,1] neg_lo:[0,1,0] neg_hi:[0,1,0]
    v_pk_fma_f32 v[76:77], v[156:157], v[22:23], v[76:77] op_sel_hi:[1,0,1] neg_lo:[0,1,0] neg_hi:[0,1,0]
    v_pk_fma_f32 v[78:79], v[158:159], v[22:23], v[78:79] op_sel_hi:[1,0,1] neg_lo:[0,1,0] neg_hi:[0,1,0]
    v_pk_mul_f32 v[128:129], v[64:65], v[64:65]
    v_pk_mul_f32 v[130:131], v[66:67], v[66:67]
    v_pk_mul_f32 v[132:133], v[68:69], v[68:69]
    v_pk_mul_f32 v[134:135], v[70:71], v[70:71]
    v_pk_mul_f32 v[136:137], v[72:73], v[72:73]
    v_pk_mul_f32 v[138:139], v[74:75], v[74:75]
    v_pk_mul_f32 v[140:141], v[76:77], v[76:77]
    v_pk_mul_f32 v[142:143], v[78:79], v[78:79]
    ds_read_b128 v[144:147], v3 offset:7552
    ds_read_b128 v[148:151], v3 offset:7584
    ds_read_b128 v[152:155], v3 offset:7616
    ds_read_b128 v[156:159], v3 offset:7648
    v_pk_fma_f32 v[128:129], v[128:129], v[24:25], v[22:23] op_sel:[0,0,1] op_sel_hi:[1,0,1]
    v_pk_fma_f32 v[130:131], v[130:131], v[24:25], v[22:23] op_sel:[0,0,1] op_sel_hi:[1,0,1]
    v_pk_fma_f32 v[132:133], v[132:133], v[24:25], v[22:23] op_sel:[0,0,1] op_sel_hi:[1,0,1]
    v_pk_fma_f32 v[134:135], v[134:135], v[24:25], v[22:23] op_sel:[0,0,1] op_sel_hi:[1,0,1]
    v_pk_fma_f32 v[136:137], v[136:137], v[24:25], v[22:23] op_sel:[0,0,1] op_sel_hi:[1,0,1]
    v_pk_fma_f32 v[138:139], v[138:139], v[24:25], v[22:23] op_sel:[0,0,1] op_sel_hi:[1,0,1]
    v_pk_fma_f32 v[140:141], v[140:141], v[24:25], v[22:23] op_sel:[0,0,1] op_sel_hi:[1,0,1]
    v_pk_fma_f32 v[142:143], v[142:143], v[24:25], v[22:23] op_sel:[0,0,1] op_sel_hi:[1,0,1]
    v_pk_mul_f32 v[128:129], v[128:129], v[64:65]
    v_pk_mul_f32 v[130:131], v[130:131], v[66:67]
    v_pk_mul_f32 v[132:133], v[132:133], v[68:69]
    v_pk_mul_f32 v[134:135], v[134:135], v[70:71]
    v_pk_mul_f32 v[136:137], v[136:137], v[72:73]
    v_pk_mul_f32 v[138:139], v[138:139], v[74:75]
    v_pk_mul_f32 v[140:141], v[140:141], v[76:77]
    v_pk_mul_f32 v[142:143], v[142:143], v[78:79]
    v_exp_f32 v128, v128
    v_exp_f32 v129, v129
    v_exp_f32 v130, v130
    v_exp_f32 v131, v131
    v_exp_f32 v132, v132
    v_exp_f32 v133, v133
    v_exp_f32 v134, v134
    v_exp_f32 v135, v135
    v_exp_f32 v136, v136
    v_exp_f32 v137, v137
    v_exp_f32 v138, v138
    v_exp_f32 v139, v139
    v_exp_f32 v140, v140
    v_exp_f32 v141, v141
    v_exp_f32 v142, v142
    v_exp_f32 v143, v143
    v_pk_fma_f32 v[128:129], v[24:25], v[128:129], v[24:25] op_sel:[1,0,1] op_sel_hi:[1,1,1]
    v_pk_fma_f32 v[130:131], v[24:25], v[130:131], v[24:25] op_sel:[1,0,1] op_sel_hi:[1,1,1]
    v_pk_fma_f32 v[132:133], v[24:25], v[132:133], v[24:25] op_sel:[1,0,1] op_sel_hi:[1,1,1]
    v_pk_fma_f32 v[134:135], v[24:25], v[134:135], v[24:25] op_sel:[1,0,1] op_sel_hi:[1,1,1]
    v_pk_fma_f32 v[136:137], v[24:25], v[136:137], v[24:25] op_sel:[1,0,1] op_sel_hi:[1,1,1]
    v_pk_fma_f32 v[138:139], v[24:25], v[138:139], v[24:25] op_sel:[1,0,1] op_sel_hi:[1,1,1]
    v_pk_fma_f32 v[140:141], v[24:25], v[140:141], v[24:25] op_sel:[1,0,1] op_sel_hi:[1,1,1]
    v_pk_fma_f32 v[142:143], v[24:25], v[142:143], v[24:25] op_sel:[1,0,1] op_sel_hi:[1,1,1]
    v_rcp_f32 v128, v128
    v_rcp_f32 v129, v129
    v_rcp_f32 v130, v130
    v_rcp_f32 v131, v131
    v_rcp_f32 v132, v132
    v_rcp_f32 v133, v133
    v_rcp_f32 v134, v134
    v_rcp_f32 v135, v135
    v_rcp_f32 v136, v136
    v_rcp_f32 v137, v137
    v_rcp_f32 v138, v138
    v_rcp_f32 v139, v139
    v_rcp_f32 v140, v140
    v_rcp_f32 v141, v141
    v_rcp_f32 v142, v142
    v_rcp_f32 v143, v143
    v_pk_mul_f32 v[128:129], v[128:129], v[64:65]
    v_pk_mul_f32 v[130:131], v[130:131], v[66:67]
    v_pk_mul_f32 v[132:133], v[132:133], v[68:69]
    v_pk_mul_f32 v[134:135], v[134:135], v[70:71]
    v_pk_mul_f32 v[136:137], v[136:137], v[72:73]
    v_pk_mul_f32 v[138:139], v[138:139], v[74:75]
    v_pk_mul_f32 v[140:141], v[140:141], v[76:77]
    v_pk_mul_f32 v[142:143], v[142:143], v[78:79]
    v_cvt_pk_bf16_f32 v64, v128, v129
    v_cvt_pk_bf16_f32 v65, v130, v131
    v_cvt_pk_bf16_f32 v66, v132, v133
    v_cvt_pk_bf16_f32 v67, v134, v135
    v_cvt_pk_bf16_f32 v68, v136, v137
    v_cvt_pk_bf16_f32 v69, v138, v139
    v_cvt_pk_bf16_f32 v70, v140, v141
    v_cvt_pk_bf16_f32 v71, v142, v143
    buffer_store_dwordx4 v[64:67], v2, s[20:23], s62 offen offset:0 sc1
    buffer_store_dwordx4 v[68:71], v2, s[20:23], s62 offen offset:1024 sc1
    s_waitcnt lgkmcnt(0)
    s_nop 0
    v_pk_fma_f32 v[80:81], v[144:145], v[22:23], v[80:81] op_sel_hi:[1,0,1] neg_lo:[0,1,0] neg_hi:[0,1,0]
    v_pk_fma_f32 v[82:83], v[146:147], v[22:23], v[82:83] op_sel_hi:[1,0,1] neg_lo:[0,1,0] neg_hi:[0,1,0]
    v_pk_fma_f32 v[84:85], v[148:149], v[22:23], v[84:85] op_sel_hi:[1,0,1] neg_lo:[0,1,0] neg_hi:[0,1,0]
    v_pk_fma_f32 v[86:87], v[150:151], v[22:23], v[86:87] op_sel_hi:[1,0,1] neg_lo:[0,1,0] neg_hi:[0,1,0]
    v_pk_fma_f32 v[88:89], v[152:153], v[22:23], v[88:89] op_sel_hi:[1,0,1] neg_lo:[0,1,0] neg_hi:[0,1,0]
    v_pk_fma_f32 v[90:91], v[154:155], v[22:23], v[90:91] op_sel_hi:[1,0,1] neg_lo:[0,1,0] neg_hi:[0,1,0]
    v_pk_fma_f32 v[92:93], v[156:157], v[22:23], v[92:93] op_sel_hi:[1,0,1] neg_lo:[0,1,0] neg_hi:[0,1,0]
    v_pk_fma_f32 v[94:95], v[158:159], v[22:23], v[94:95] op_sel_hi:[1,0,1] neg_lo:[0,1,0] neg_hi:[0,1,0]
    v_pk_mul_f32 v[128:129], v[80:81], v[80:81]
    v_pk_mul_f32 v[130:131], v[82:83], v[82:83]
    v_pk_mul_f32 v[132:133], v[84:85], v[84:85]
    v_pk_mul_f32 v[134:135], v[86:87], v[86:87]
    v_pk_mul_f32 v[136:137], v[88:89], v[88:89]
    v_pk_mul_f32 v[138:139], v[90:91], v[90:91]
    v_pk_mul_f32 v[140:141], v[92:93], v[92:93]
    v_pk_mul_f32 v[142:143], v[94:95], v[94:95]
    v_pk_fma_f32 v[128:129], v[128:129], v[24:25], v[22:23] op_sel:[0,0,1] op_sel_hi:[1,0,1]
    v_pk_fma_f32 v[130:131], v[130:131], v[24:25], v[22:23] op_sel:[0,0,1] op_sel_hi:[1,0,1]
    v_pk_fma_f32 v[132:133], v[132:133], v[24:25], v[22:23] op_sel:[0,0,1] op_sel_hi:[1,0,1]
    v_pk_fma_f32 v[134:135], v[134:135], v[24:25], v[22:23] op_sel:[0,0,1] op_sel_hi:[1,0,1]
    v_pk_fma_f32 v[136:137], v[136:137], v[24:25], v[22:23] op_sel:[0,0,1] op_sel_hi:[1,0,1]
    v_pk_fma_f32 v[138:139], v[138:139], v[24:25], v[22:23] op_sel:[0,0,1] op_sel_hi:[1,0,1]
    v_pk_fma_f32 v[140:141], v[140:141], v[24:25], v[22:23] op_sel:[0,0,1] op_sel_hi:[1,0,1]
    v_pk_fma_f32 v[142:143], v[142:143], v[24:25], v[22:23] op_sel:[0,0,1] op_sel_hi:[1,0,1]
    v_pk_mul_f32 v[128:129], v[128:129], v[80:81]
    v_pk_mul_f32 v[130:131], v[130:131], v[82:83]
    v_pk_mul_f32 v[132:133], v[132:133], v[84:85]
    v_pk_mul_f32 v[134:135], v[134:135], v[86:87]
    v_pk_mul_f32 v[136:137], v[136:137], v[88:89]
    v_pk_mul_f32 v[138:139], v[138:139], v[90:91]
    v_pk_mul_f32 v[140:141], v[140:141], v[92:93]
    v_pk_mul_f32 v[142:143], v[142:143], v[94:95]
    v_exp_f32 v128, v128
    v_exp_f32 v129, v129
    v_exp_f32 v130, v130
    v_exp_f32 v131, v131
    v_exp_f32 v132, v132
    v_exp_f32 v133, v133
    v_exp_f32 v134, v134
    v_exp_f32 v135, v135
    v_exp_f32 v136, v136
    v_exp_f32 v137, v137
    v_exp_f32 v138, v138
    v_exp_f32 v139, v139
    v_exp_f32 v140, v140
    v_exp_f32 v141, v141
    v_exp_f32 v142, v142
    v_exp_f32 v143, v143
    v_pk_fma_f32 v[128:129], v[24:25], v[128:129], v[24:25] op_sel:[1,0,1] op_sel_hi:[1,1,1]
    v_pk_fma_f32 v[130:131], v[24:25], v[130:131], v[24:25] op_sel:[1,0,1] op_sel_hi:[1,1,1]
    v_pk_fma_f32 v[132:133], v[24:25], v[132:133], v[24:25] op_sel:[1,0,1] op_sel_hi:[1,1,1]
    v_pk_fma_f32 v[134:135], v[24:25], v[134:135], v[24:25] op_sel:[1,0,1] op_sel_hi:[1,1,1]
    v_pk_fma_f32 v[136:137], v[24:25], v[136:137], v[24:25] op_sel:[1,0,1] op_sel_hi:[1,1,1]
    v_pk_fma_f32 v[138:139], v[24:25], v[138:139], v[24:25] op_sel:[1,0,1] op_sel_hi:[1,1,1]
    v_pk_fma_f32 v[140:141], v[24:25], v[140:141], v[24:25] op_sel:[1,0,1] op_sel_hi:[1,1,1]
    v_pk_fma_f32 v[142:143], v[24:25], v[142:143], v[24:25] op_sel:[1,0,1] op_sel_hi:[1,1,1]
    v_add_u32 v28, 40960, v26
    v_add_u32 v29, 40960, v27
    ds_read_b64_tr_b16 v[48:49], v28 offset:0
    ds_read_b64_tr_b16 v[50:51], v28 offset:1024
    ds_read_b64_tr_b16 v[52:53], v29 offset:0
    ds_read_b64_tr_b16 v[54:55], v29 offset:1024
    ds_read_b64_tr_b16 v[56:57], v28 offset:2048
    ds_read_b64_tr_b16 v[58:59], v28 offset:3072
    ds_read_b64_tr_b16 v[60:61], v29 offset:2048
    ds_read_b64_tr_b16 v[62:63], v29 offset:3072
    ds_read_b64_tr_b16 v[144:145], v28 offset:4096
    ds_read_b64_tr_b16 v[146:147], v28 offset:5120
    ds_read_b64_tr_b16 v[148:149], v29 offset:4096
    ds_read_b64_tr_b16 v[150:151], v29 offset:5120
    ds_read_b64_tr_b16 v[152:153], v28 offset:6144
    ds_read_b64_tr_b16 v[154:155], v28 offset:7168
    ds_read_b64_tr_b16 v[156:157], v29 offset:6144
    ds_read_b64_tr_b16 v[158:159], v29 offset:7168
    v_rcp_f32 v128, v128
    v_rcp_f32 v129, v129
    v_rcp_f32 v130, v130
    v_rcp_f32 v131, v131
    v_rcp_f32 v132, v132
    v_rcp_f32 v133, v133
    v_rcp_f32 v134, v134
    v_rcp_f32 v135, v135
    v_rcp_f32 v136, v136
    v_rcp_f32 v137, v137
    v_rcp_f32 v138, v138
    v_rcp_f32 v139, v139
    v_rcp_f32 v140, v140
    v_rcp_f32 v141, v141
    v_rcp_f32 v142, v142
    v_rcp_f32 v143, v143
    v_pk_mul_f32 v[128:129], v[128:129], v[80:81]
    v_pk_mul_f32 v[130:131], v[130:131], v[82:83]
    v_pk_mul_f32 v[132:133], v[132:133], v[84:85]
    v_pk_mul_f32 v[134:135], v[134:135], v[86:87]
    v_pk_mul_f32 v[136:137], v[136:137], v[88:89]
    v_pk_mul_f32 v[138:139], v[138:139], v[90:91]
    v_pk_mul_f32 v[140:141], v[140:141], v[92:93]
    v_pk_mul_f32 v[142:143], v[142:143], v[94:95]
    v_cvt_pk_bf16_f32 v72, v128, v129
    v_cvt_pk_bf16_f32 v73, v130, v131
    v_cvt_pk_bf16_f32 v74, v132, v133
    v_cvt_pk_bf16_f32 v75, v134, v135
    v_cvt_pk_bf16_f32 v76, v136, v137
    v_cvt_pk_bf16_f32 v77, v138, v139
    v_cvt_pk_bf16_f32 v78, v140, v141
    v_cvt_pk_bf16_f32 v79, v142, v143
    buffer_store_dwordx4 v[72:75], v2, s[20:23], s62 offen offset:2048 sc1
    buffer_store_dwordx4 v[76:79], v2, s[20:23], s62 offen offset:3072 sc1
    s_waitcnt lgkmcnt(8)
    s_nop 0
    v_mfma_f32_32x32x16_bf16 v[96:111], v[48:51], v[224:227], v[96:111]
    ds_read_b64_tr_b16 v[128:129], v28 offset:8192
    ds_read_b64_tr_b16 v[130:131], v28 offset:9216
    v_mfma_f32_32x32x16_bf16 v[112:127], v[52:55], v[224:227], v[112:127]
    ds_read_b64_tr_b16 v[132:133], v29 offset:8192
    ds_read_b64_tr_b16 v[134:135], v29 offset:9216
    ds_read_b64_tr_b16 v[136:137], v28 offset:10240
    v_mfma_f32_32x32x16_bf16 v[96:111], v[56:59], v[228:231], v[96:111]
    ds_read_b64_tr_b16 v[138:139], v28 offset:11264
    ds_read_b64_tr_b16 v[140:141], v29 offset:10240
    v_mfma_f32_32x32x16_bf16 v[112:127], v[60:63], v[228:231], v[112:127]
    ds_read_b64_tr_b16 v[142:143], v29 offset:11264
    s_waitcnt lgkmcnt(8)
    s_nop 0
    v_mfma_f32_32x32x16_bf16 v[96:111], v[144:147], v[232:235], v[96:111]
    ds_read_b64_tr_b16 v[48:49], v28 offset:12288
    ds_read_b64_tr_b16 v[50:51], v28 offset:13312
    v_mfma_f32_32x32x16_bf16 v[112:127], v[148:151], v[232:235], v[112:127]
    ds_read_b64_tr_b16 v[52:53], v29 offset:12288
    ds_read_b64_tr_b16 v[54:55], v29 offset:13312
    ds_read_b64_tr_b16 v[56:57], v28 offset:14336
    v_mfma_f32_32x32x16_bf16 v[96:111], v[152:155], v[236:239], v[96:111]
    ds_read_b64_tr_b16 v[58:59], v28 offset:15360
    ds_read_b64_tr_b16 v[60:61], v29 offset:14336
    v_mfma_f32_32x32x16_bf16 v[112:127], v[156:159], v[236:239], v[112:127]
    ds_read_b64_tr_b16 v[62:63], v29 offset:15360
    s_waitcnt lgkmcnt(8)
    s_nop 0
    v_mfma_f32_32x32x16_bf16 v[96:111], v[128:131], v[240:243], v[96:111]
    s_xor_b32 s31, s48, 2105344
    buffer_load_dwordx4 v[224:227], v5, s[20:23], s31 offen offset:0 sc1
    v_add_u32 v28, 139264, v26
    v_add_u32 v29, 139264, v27
    v_mfma_f32_32x32x16_bf16 v[112:127], v[132:135], v[240:243], v[112:127]
    ds_read_b64_tr_b16 v[144:145], v28 offset:0
    ds_read_b64_tr_b16 v[146:147], v28 offset:1024
    ds_read_b64_tr_b16 v[148:149], v29 offset:0
    v_mfma_f32_32x32x16_bf16 v[96:111], v[136:139], v[244:247], v[96:111]
    buffer_load_dwordx4 v[228:231], v5, s[20:23], s31 offen offset:1024 sc1
    ds_read_b64_tr_b16 v[150:151], v29 offset:1024
    ds_read_b64_tr_b16 v[152:153], v28 offset:2048
    v_mfma_f32_32x32x16_bf16 v[112:127], v[140:143], v[244:247], v[112:127]
    ds_read_b64_tr_b16 v[154:155], v28 offset:3072
    ds_read_b64_tr_b16 v[156:157], v29 offset:2048
    ds_read_b64_tr_b16 v[158:159], v29 offset:3072
    s_waitcnt lgkmcnt(8)
    s_barrier
    v_mfma_f32_32x32x16_bf16 v[96:111], v[48:51], v[248:251], v[96:111]
    buffer_load_dwordx4 v[232:235], v5, s[20:23], s31 offen offset:2048 sc1
    ds_read_b64_tr_b16 v[128:129], v28 offset:4096
    ds_read_b64_tr_b16 v[130:131], v28 offset:5120
    v_mfma_f32_32x32x16_bf16 v[112:127], v[52:55], v[248:251], v[112:127]
    ds_read_b64_tr_b16 v[132:133], v29 offset:4096
    ds_read_b64_tr_b16 v[134:135], v29 offset:5120
    ds_read_b64_tr_b16 v[136:137], v28 offset:6144
    v_mfma_f32_32x32x16_bf16 v[96:111], v[56:59], v[252:255], v[96:111]
    buffer_load_dwordx4 v[236:239], v5, s[20:23], s31 offen offset:3072 sc1
    ds_read_b64_tr_b16 v[138:139], v28 offset:7168
    ds_read_b64_tr_b16 v[140:141], v29 offset:6144
    v_mfma_f32_32x32x16_bf16 v[112:127], v[60:63], v[252:255], v[112:127]
    ds_read_b64_tr_b16 v[142:143], v29 offset:7168
    s_waitcnt lgkmcnt(8)
    s_nop 0
    v_mfma_f32_32x32x16_bf16 v[96:111], v[144:147], v[160:163], v[96:111]
    s_xor_b32 s31, s48, 2109440
    buffer_load_dwordx4 v[240:243], v5, s[20:23], s31 offen offset:0 sc1
    ds_read_b64_tr_b16 v[48:49], v28 offset:8192
    ds_read_b64_tr_b16 v[50:51], v28 offset:9216
    v_mfma_f32_32x32x16_bf16 v[112:127], v[148:151], v[160:163], v[112:127]
    ds_read_b64_tr_b16 v[52:53], v29 offset:8192
    ds_read_b64_tr_b16 v[54:55], v29 offset:9216
    ds_read_b64_tr_b16 v[56:57], v28 offset:10240
    v_mfma_f32_32x32x16_bf16 v[96:111], v[152:155], v[164:167], v[96:111]
    buffer_load_dwordx4 v[244:247], v5, s[20:23], s31 offen offset:1024 sc1
    ds_read_b64_tr_b16 v[58:59], v28 offset:11264
    ds_read_b64_tr_b16 v[60:61], v29 offset:10240
    v_mfma_f32_32x32x16_bf16 v[112:127], v[156:159], v[164:167], v[112:127]
    ds_read_b64_tr_b16 v[62:63], v29 offset:11264
    s_waitcnt lgkmcnt(8)
    s_nop 0
    v_mfma_f32_32x32x16_bf16 v[96:111], v[128:131], v[168:171], v[96:111]
    buffer_load_dwordx4 v[248:251], v5, s[20:23], s31 offen offset:2048 sc1
    ds_read_b64_tr_b16 v[144:145], v28 offset:12288
    ds_read_b64_tr_b16 v[146:147], v28 offset:13312
    v_mfma_f32_32x32x16_bf16 v[112:127], v[132:135], v[168:171], v[112:127]
    ds_read_b64_tr_b16 v[148:149], v29 offset:12288
    ds_read_b64_tr_b16 v[150:151], v29 offset:13312
    ds_read_b64_tr_b16 v[152:153], v28 offset:14336
    v_mfma_f32_32x32x16_bf16 v[96:111], v[136:139], v[172:175], v[96:111]
    buffer_load_dwordx4 v[252:255], v5, s[20:23], s31 offen offset:3072 sc1
    ds_read_b64_tr_b16 v[154:155], v28 offset:15360
    ds_read_b64_tr_b16 v[156:157], v29 offset:14336
    v_mfma_f32_32x32x16_bf16 v[112:127], v[140:143], v[172:175], v[112:127]
    ds_read_b64_tr_b16 v[158:159], v29 offset:15360
    s_waitcnt vmcnt(8)
    s_cmp_eq_u32 s45, 0
    s_cbranch_scc1 SAFE_19
    buffer_store_dword v15, v14, s[20:23], s57 offen offset:768
STD_20:
    s_waitcnt lgkmcnt(8)
    s_barrier
    s_nop 0
    v_mfma_f32_32x32x16_bf16 v[96:111], v[48:51], v[176:179], v[96:111]
    v_add_u32 v18, 8192, v20
    v_add_u32 v19, 8192, v21
    v_mfma_f32_32x32x16_bf16 v[112:127], v[52:55], v[176:179], v[112:127]
    ds_read_b64_tr_b16 v[128:129], v18 offset:0
    ds_read_b64_tr_b16 v[130:131], v18 offset:512
    ds_read_b64_tr_b16 v[132:133], v19 offset:0
    v_mfma_f32_32x32x16_bf16 v[96:111], v[56:59], v[180:183], v[96:111]
    ds_read_b64_tr_b16 v[134:135], v19 offset:512
    ds_read_b64_tr_b16 v[136:137], v18 offset:2048
    v_mfma_f32_32x32x16_bf16 v[112:127], v[60:63], v[180:183], v[112:127]
    ds_read_b64_tr_b16 v[138:139], v18 offset:2560
    ds_read_b64_tr_b16 v[140:141], v19 offset:2048
    ds_read_b64_tr_b16 v[142:143], v19 offset:2560
    s_waitcnt lgkmcnt(8)
    s_barrier
    v_mfma_f32_32x32x16_bf16 v[96:111], v[144:147], v[184:187], v[96:111]
    ds_read_b64_tr_b16 v[48:49], v18 offset:4096
    ds_read_b64_tr_b16 v[50:51], v18 offset:4608
    v_mfma_f32_32x32x16_bf16 v[112:127], v[148:151], v[184:187], v[112:127]
    ds_read_b64_tr_b16 v[52:53], v19 offset:4096
    ds_read_b64_tr_b16 v[54:55], v19 offset:4608
    ds_read_b64_tr_b16 v[56:57], v18 offset:6144
    v_mfma_f32_32x32x16_bf16 v[96:111], v[152:155], v[188:191], v[96:111]
    ds_read_b64_tr_b16 v[58:59], v18 offset:6656
    ds_read_b64_tr_b16 v[60:61], v19 offset:6144
    v_mfma_f32_32x32x16_bf16 v[112:127], v[156:159], v[188:191], v[112:127]
    ds_read_b64_tr_b16 v[62:63], v19 offset:6656
    s_waitcnt lgkmcnt(8)
L_JOIN0:
    s_nop 0
    v_mfma_f32_32x32x16_bf16 v[32:47], v[128:131], v[192:195], v[32:47]
    v_add_u32 v18, 90112, v20
    v_add_u32 v19, 90112, v21
    v_mfma_f32_32x32x16_bf16 v[80:95], v[132:135], v[192:195], 0
    ds_read_b64_tr_b16 v[144:145], v18 offset:0
    ds_read_b64_tr_b16 v[146:147], v18 offset:512
    ds_read_b64_tr_b16 v[148:149], v19 offset:0
    v_mfma_f32_32x32x16_bf16 v[32:47], v[136:139], v[196:199], v[32:47]
    ds_read_b64_tr_b16 v[150:151], v19 offset:512
    ds_read_b64_tr_b16 v[152:153], v18 offset:2048
    v_mfma_f32_32x32x16_bf16 v[80:95], v[140:143], v[196:199], v[80:95]
    ds_read_b64_tr_b16 v[154:155], v18 offset:2560
    ds_read_b64_tr_b16 v[156:157], v19 offset:2048
    ds_read_b64_tr_b16 v[158:159], v19 offset:2560
    s_waitcnt lgkmcnt(8)
    s_nop 0
    v_mfma_f32_32x32x16_bf16 v[32:47], v[48:51], v[200:203], v[32:47]
    ds_read_b64_tr_b16 v[128:129], v18 offset:4096
    ds_read_b64_tr_b16 v[130:131], v18 offset:4608
    v_mfma_f32_32x32x16_bf16 v[80:95], v[52:55], v[200:203], v[80:95]
    ds_read_b64_tr_b16 v[132:133], v19 offset:4096
    ds_read_b64_tr_b16 v[134:135], v19 offset:4608
    ds_read_b64_tr_b16 v[136:137], v18 offset:6144
    v_mfma_f32_32x32x16_bf16 v[32:47], v[56:59], v[204:207], v[32:47]
    ds_read_b64_tr_b16 v[138:139], v18 offset:6656
    ds_read_b64_tr_b16 v[140:141], v19 offset:6144
    v_mfma_f32_32x32x16_bf16 v[80:95], v[60:63], v[204:207], v[80:95]
    ds_read_b64_tr_b16 v[142:143], v19 offset:6656
    buffer_load_dword v17, v9, s[20:23], s60 offen offset:768 sc1
    s_waitcnt lgkmcnt(8)
    s_nop 0
    ds_read_b128 v[48:51], v3 offset:7680
    ds_read_b128 v[52:55], v3 offset:7712
    ds_read_b128 v[56:59], v3 offset:7744
    ds_read_b128 v[60:63], v3 offset:7776
    v_mfma_f32_32x32x16_bf16 v[32:47], v[144:147], v[208:211], v[32:47]
    v_mfma_f32_32x32x16_bf16 v[80:95], v[148:151], v[208:211], v[80:95]
    v_mfma_f32_32x32x16_bf16 v[32:47], v[152:155], v[212:215], v[32:47]
    v_mfma_f32_32x32x16_bf16 v[80:95], v[156:159], v[212:215], v[80:95]
    s_waitcnt lgkmcnt(4)
    s_barrier
    v_mfma_f32_32x32x16_bf16 v[32:47], v[128:131], v[216:219], v[32:47]
    v_mfma_f32_32x32x16_bf16 v[80:95], v[132:135], v[216:219], v[80:95]
    v_mfma_f32_32x32x16_bf16 v[32:47], v[136:139], v[220:223], v[32:47]
    v_mfma_f32_32x32x16_bf16 v[80:95], v[140:143], v[220:223], v[80:95]
    s_cmp_ge_u32 s7, 14
    s_cbranch_scc1 L_IDLE1
    s_mul_i32 s25, s18, 8256
    v_xor_b32 v26, s25, v26
    v_xor_b32_e64 v27, 64, v26
    s_waitcnt lgkmcnt(0)
    v_pk_fma_f32 v[96:97], v[48:49], v[22:23], v[96:97] op_sel_hi:[1,0,1] neg_lo:[0,1,0] neg_hi:[0,1,0]
    v_pk_fma_f32 v[98:99], v[50:51], v[22:23], v[98:99] op_sel_hi:[1,0,1] neg_lo:[0,1,0] neg_hi:[0,1,0]
    v_pk_fma_f32 v[100:101], v[52:53], v[22:23], v[100:101] op_sel_hi:[1,0,1] neg_lo:[0,1,0] neg_hi:[0,1,0]
    v_pk_fma_f32 v[102:103], v[54:55], v[22:23], v[102:103] op_sel_hi:[1,0,1] neg_lo:[0,1,0] neg_hi:[0,1,0]
    v_pk_fma_f32 v[104:105], v[56:57], v[22:23], v[104:105] op_sel_hi:[1,0,1] neg_lo:[0,1,0] neg_hi:[0,1,0]
    v_pk_fma_f32 v[106:107], v[58:59], v[22:23], v[106:107] op_sel_hi:[1,0,1] neg_lo:[0,1,0] neg_hi:[0,1,0]
    v_pk_fma_f32 v[108:109], v[60:61], v[22:23], v[108:109] op_sel_hi:[1,0,1] neg_lo:[0,1,0] neg_hi:[0,1,0]
    v_pk_fma_f32 v[110:111], v[62:63], v[22:23], v[110:111] op_sel_hi:[1,0,1] neg_lo:[0,1,0] neg_hi:[0,1,0]
    v_pk_mul_f32 v[144:145], v[96:97], v[96:97]
    v_pk_mul_f32 v[146:147], v[98:99], v[98:99]
    v_pk_mul_f32 v[148:149], v[100:101], v[100:101]
    v_pk_mul_f32 v[150:151], v[102:103], v[102:103]
    v_pk_mul_f32 v[152:153], v[104:105], v[104:105]
    v_pk_mul_f32 v[154:155], v[106:107], v[106:107]
    v_pk_mul_f32 v[156:157], v[108:109], v[108:109]
    v_pk_mul_f32 v[158:159], v[110:111], v[110:111]
    ds_read_b128 v[48:51], v3 offset:7808
    ds_read_b128 v[52:55], v3 offset:7840
    ds_read_b128 v[56:59], v3 offset:7872
    ds_read_b128 v[60:63], v3 offset:7904
    v_pk_fma_f32 v[144:145], v[144:145], v[24:25], v[22:23] op_sel:[0,0,1] op_sel_hi:[1,0,1]
    v_pk_fma_f32 v[146:147], v[146:147], v[24:25], v[22:23] op_sel:[0,0,1] op_sel_hi:[1,0,1]
    v_pk_fma_f32 v[148:149], v[148:149], v[24:25], v[22:23] op_sel:[0,0,1] op_sel_hi:[1,0,1]
    v_pk_fma_f32 v[150:151], v[150:151], v[24:25], v[22:23] op_sel:[0,0,1] op_sel_hi:[1,0,1]
    v_pk_fma_f32 v[152:153], v[152:153], v[24:25], v[22:23] op_sel:[0,0,1] op_sel_hi:[1,0,1]
    v_pk_fma_f32 v[154:155], v[154:155], v[24:25], v[22:23] op_sel:[0,0,1] op_sel_hi:[1,0,1]
    v_pk_fma_f32 v[156:157], v[156:157], v[24:25], v[22:23] op_sel:[0,0,1] op_sel_hi:[1,0,1]
    v_pk_fma_f32 v[158:159], v[158:159], v[24:25], v[22:23] op_sel:[0,0,1] op_sel_hi:[1,0,1]
    v_pk_mul_f32 v[144:145], v[144:145], v[96:97]
    v_pk_mul_f32 v[146:147], v[146:147], v[98:99]
    v_pk_mul_f32 v[148:149], v[148:149], v[100:101]
    v_pk_mul_f32 v[150:151], v[150:151], v[102:103]
    v_pk_mul_f32 v[152:153], v[152:153], v[104:105]
    v_pk_mul_f32 v[154:155], v[154:155], v[106:107]
    v_pk_mul_f32 v[156:157], v[156:157], v[108:109]
    v_pk_mul_f32 v[158:159], v[158:159], v[110:111]
    v_exp_f32 v144, v144
    v_exp_f32 v145, v145
    v_exp_f32 v146, v146
    v_exp_f32 v147, v147
    v_exp_f32 v148, v148
    v_exp_f32 v149, v149
    v_exp_f32 v150, v150
    v_exp_f32 v151, v151
    v_exp_f32 v152, v152
    v_exp_f32 v153, v153
    v_exp_f32 v154, v154
    v_exp_f32 v155, v155
    v_exp_f32 v156, v156
    v_exp_f32 v157, v157
    v_exp_f32 v158, v158
    v_exp_f32 v159, v159
    s_waitcnt vmcnt(0)
SPIN_21:
    v_cmp_ne_u32 vcc, 1, v17
    s_nop 0
    s_cbranch_vccnz RETRY_22
DONE_23:
    v_pk_fma_f32 v[144:145], v[24:25], v[144:145], v[24:25] op_sel:[1,0,1] op_sel_hi:[1,1,1]
    s_add_u32 s31, s63, s50
    s_nop 0
    buffer_load_dwordx4 v[160:163], v5, s[20:23], s31 offen offset:0 sc1
    v_pk_fma_f32 v[146:147], v[24:25], v[146:147], v[24:25] op_sel:[1,0,1] op_sel_hi:[1,1,1]
    v_pk_fma_f32 v[148:149], v[24:25], v[148:149], v[24:25] op_sel:[1,0,1] op_sel_hi:[1,1,1]
    v_pk_fma_f32 v[150:151], v[24:25], v[150:151], v[24:25] op_sel:[1,0,1] op_sel_hi:[1,1,1]
    v_pk_fma_f32 v[152:153], v[24:25], v[152:153], v[24:25] op_sel:[1,0,1] op_sel_hi:[1,1,1]
    v_pk_fma_f32 v[154:155], v[24:25], v[154:155], v[24:25] op_sel:[1,0,1] op_sel_hi:[1,1,1]
    v_pk_fma_f32 v[156:157], v[24:25], v[156:157], v[24:25] op_sel:[1,0,1] op_sel_hi:[1,1,1]
    v_pk_fma_f32 v[158:159], v[24:25], v[158:159], v[24:25] op_sel:[1,0,1] op_sel_hi:[1,1,1]
    v_rcp_f32 v144, v144
    v_rcp_f32 v145, v145
    v_rcp_f32_e64 v146, v146
    buffer_load_dwordx4 v[164:167], v5, s[20:23], s31 offen offset:1024 sc1
    v_rcp_f32 v147, v147
    v_rcp_f32 v148, v148
    v_rcp_f32 v149, v149
    v_rcp_f32 v150, v150
    v_rcp_f32 v151, v151
    v_rcp_f32 v152, v152
    buffer_load_dwordx4 v[168:171], v5, s[20:23], s31 offen offset:2048 sc1
    v_rcp_f32 v153, v153
    v_rcp_f32 v154, v154
    v_rcp_f32 v155, v155
    v_rcp_f32 v156, v156
    v_rcp_f32 v157, v157
    v_rcp_f32 v158, v158
    buffer_load_dwordx4 v[172:175], v5, s[20:23], s31 offen offset:3072 sc1
    v_rcp_f32_e64 v159, v159
    v_pk_mul_f32 v[144:145], v[144:145], v[96:97]
    v_pk_mul_f32 v[146:147], v[146:147], v[98:99]
    v_pk_mul_f32 v[148:149], v[148:149], v[100:101]
    v_pk_mul_f32 v[150:151], v[150:151], v[102:103]
    v_pk_mul_f32 v[152:153], v[152:153], v[104:105]
    v_pk_mul_f32 v[154:155], v[154:155], v[106:107]
    v_pk_mul_f32 v[156:157], v[156:157], v[108:109]
    v_pk_mul_f32 v[158:159], v[158:159], v[110:111]
    v_cvt_pk_bf16_f32 v96, v144, v145
    v_cvt_pk_bf16_f32 v97, v146, v147
    s_add_u32 s31, s64, s50
    s_nop 0
    buffer_load_dwordx4 v[176:179], v5, s[20:23], s31 offen offset:0 sc1
    v_cvt_pk_bf16_f32 v98, v148, v149
    v_cvt_pk_bf16_f32 v99, v150, v151
    v_cvt_pk_bf16_f32 v100, v152, v153
    v_cvt_pk_bf16_f32 v101, v154, v155
    v_cvt_pk_bf16_f32 v102, v156, v157
    v_cvt_pk_bf16_f32 v103, v158, v159
    s_addk_i32 s62, 4096
    buffer_store_dwordx4 v[96:99], v2, s[20:23], s62 offen offset:0 sc1
    buffer_store_dwordx4 v[100:103], v2, s[20:23], s62 offen offset:1024 sc1
    s_waitcnt lgkmcnt(0)
    v_pk_fma_f32 v[112:113], v[48:49], v[22:23], v[112:113] op_sel_hi:[1,0,1] neg_lo:[0,1,0] neg_hi:[0,1,0]
    v_pk_fma_f32 v[114:115], v[50:51], v[22:23], v[114:115] op_sel_hi:[1,0,1] neg_lo:[0,1,0] neg_hi:[0,1,0]
    v_pk_fma_f32 v[116:117], v[52:53], v[22:23], v[116:117] op_sel_hi:[1,0,1] neg_lo:[0,1,0] neg_hi:[0,1,0]
    v_pk_fma_f32 v[118:119], v[54:55], v[22:23], v[118:119] op_sel_hi:[1,0,1] neg_lo:[0,1,0] neg_hi:[0,1,0]
    v_pk_fma_f32 v[120:121], v[56:57], v[22:23], v[120:121] op_sel_hi:[1,0,1] neg_lo:[0,1,0] neg_hi:[0,1,0]
    v_pk_fma_f32 v[122:123], v[58:59], v[22:23], v[122:123] op_sel_hi:[1,0,1] neg_lo:[0,1,0] neg_hi:[0,1,0]
    v_pk_fma_f32 v[124:125], v[60:61], v[22:23], v[124:125] op_sel_hi:[1,0,1] neg_lo:[0,1,0] neg_hi:[0,1,0]
    v_pk_fma_f32 v[126:127], v[62:63], v[22:23], v[126:127] op_sel_hi:[1,0,1] neg_lo:[0,1,0] neg_hi:[0,1,0]
    v_pk_mul_f32 v[144:145], v[112:113], v[112:113]
    v_pk_mul_f32 v[146:147], v[114:115], v[114:115]
    v_pk_mul_f32 v[148:149], v[116:117], v[116:117]
    buffer_load_dwordx4 v[180:183], v5, s[20:23], s31 offen offset:1024 sc1
    v_pk_mul_f32 v[150:151], v[118:119], v[118:119]
    v_pk_mul_f32 v[152:153], v[120:121], v[120:121]
    v_pk_mul_f32 v[154:155], v[122:123], v[122:123]
    v_pk_mul_f32 v[156:157], v[124:125], v[124:125]
    v_pk_mul_f32 v[158:159], v[126:127], v[126:127]
    v_pk_fma_f32 v[144:145], v[144:145], v[24:25], v[22:23] op_sel:[0,0,1] op_sel_hi:[1,0,1]
    v_pk_fma_f32 v[146:147], v[146:147], v[24:25], v[22:23] op_sel:[0,0,1] op_sel_hi:[1,0,1]
    v_pk_fma_f32 v[148:149], v[148:149], v[24:25], v[22:23] op_sel:[0,0,1] op_sel_hi:[1,0,1]
    v_pk_fma_f32 v[150:151], v[150:151], v[24:25], v[22:23] op_sel:[0,0,1] op_sel_hi:[1,0,1]
    v_pk_fma_f32 v[152:153], v[152:153], v[24:25], v[22:23] op_sel:[0,0,1] op_sel_hi:[1,0,1]
    v_pk_fma_f32 v[154:155], v[154:155], v[24:25], v[22:23] op_sel:[0,0,1] op_sel_hi:[1,0,1]
    v_pk_fma_f32 v[156:157], v[156:157], v[24:25], v[22:23] op_sel:[0,0,1] op_sel_hi:[1,0,1]
    buffer_load_dwordx4 v[184:187], v5, s[20:23], s31 offen offset:2048 sc1
    v_pk_fma_f32 v[158:159], v[158:159], v[24:25], v[22:23] op_sel:[0,0,1] op_sel_hi:[1,0,1]
    v_pk_mul_f32 v[144:145], v[144:145], v[112:113]
    v_pk_mul_f32 v[146:147], v[146:147], v[114:115]
    v_pk_mul_f32 v[148:149], v[148:149], v[116:117]
    v_pk_mul_f32 v[150:151], v[150:151], v[118:119]
    v_pk_mul_f32 v[152:153], v[152:153], v[120:121]
    v_pk_mul_f32 v[154:155], v[154:155], v[122:123]
    v_pk_mul_f32 v[156:157], v[156:157], v[124:125]
    v_pk_mul_f32 v[158:159], v[158:159], v[126:127]
    v_exp_f32 v144, v144
    v_exp_f32 v145, v145
    buffer_load_dwordx4 v[188:191], v5, s[20:23], s31 offen offset:3072 sc1
    v_exp_f32 v146, v146
    v_exp_f32 v147, v147
    v_exp_f32 v148, v148
    v_exp_f32 v149, v149
    v_exp_f32 v150, v150
    v_exp_f32_e64 v151, v151
    s_add_u32 s31, s65, s50
    buffer_load_dwordx4 v[192:195], v5, s[20:23], s31 offen offset:0 sc1
    v_exp_f32 v152, v152
    v_exp_f32 v153, v153
    v_exp_f32 v154, v154
    v_exp_f32 v155, v155
    v_exp_f32 v156, v156
    v_exp_f32 v157, v157
    buffer_load_dwordx4 v[196:199], v5, s[20:23], s31 offen offset:1024 sc1
    v_exp_f32 v158, v158
    v_exp_f32 v159, v159
    v_pk_fma_f32 v[144:145], v[24:25], v[144:145], v[24:25] op_sel:[1,0,1] op_sel_hi:[1,1,1]
    v_pk_fma_f32 v[146:147], v[24:25], v[146:147], v[24:25] op_sel:[1,0,1] op_sel_hi:[1,1,1]
    v_pk_fma_f32 v[148:149], v[24:25], v[148:149], v[24:25] op_sel:[1,0,1] op_sel_hi:[1,1,1]
    v_pk_fma_f32 v[150:151], v[24:25], v[150:151], v[24:25] op_sel:[1,0,1] op_sel_hi:[1,1,1]
    v_pk_fma_f32 v[152:153], v[24:25], v[152:153], v[24:25] op_sel:[1,0,1] op_sel_hi:[1,1,1]
    v_pk_fma_f32 v[154:155], v[24:25], v[154:155], v[24:25] op_sel:[1,0,1] op_sel_hi:[1,1,1]
    v_pk_fma_f32 v[156:157], v[24:25], v[156:157], v[24:25] op_sel:[1,0,1] op_sel_hi:[1,1,1]
    v_pk_fma_f32 v[158:159], v[24:25], v[158:159], v[24:25] op_sel:[1,0,1] op_sel_hi:[1,1,1]
    buffer_load_dwordx4 v[200:203], v5, s[20:23], s31 offen offset:2048 sc1
    s_barrier
    s_nop 0
    v_add_u32 v18, 57344, v20
    v_add_u32 v19, 57344, v21
    ds_read_b64_tr_b16 v[128:129], v18 offset:0
    ds_read_b64_tr_b16 v[130:131], v18 offset:512
    ds_read_b64_tr_b16 v[132:133], v19 offset:0
    ds_read_b64_tr_b16 v[134:135], v19 offset:512
    ds_read_b64_tr_b16 v[136:137], v18 offset:2048
    ds_read_b64_tr_b16 v[138:139], v18 offset:2560
    buffer_load_dwordx4 v[204:207], v5, s[20:23], s31 offen offset:3072 sc1
    ds_read_b64_tr_b16 v[140:141], v19 offset:2048
    ds_read_b64_tr_b16 v[142:143], v19 offset:2560
    ds_read_b64_tr_b16 v[64:65], v18 offset:4096
    ds_read_b64_tr_b16 v[66:67], v18 offset:4608
    ds_read_b64_tr_b16 v[68:69], v19 offset:4096
    ds_read_b64_tr_b16 v[70:71], v19 offset:4608
    ds_read_b64_tr_b16 v[72:73], v18 offset:6144
    ds_read_b64_tr_b16 v[74:75], v18 offset:6656
    s_add_u32 s31, s66, s50
    buffer_load_dwordx4 v[208:211], v5, s[20:23], s31 offen offset:0 sc1
    ds_read_b64_tr_b16 v[76:77], v19 offset:6144
    ds_read_b64_tr_b16 v[78:79], v19 offset:6656
    v_rcp_f32 v144, v144
    v_rcp_f32 v145, v145
    v_rcp_f32 v146, v146
    v_rcp_f32 v147, v147
    v_rcp_f32 v148, v148
    buffer_load_dwordx4 v[212:215], v5, s[20:23], s31 offen offset:1024 sc1
    v_rcp_f32 v149, v149
    v_rcp_f32 v150, v150
    v_rcp_f32 v151, v151
    v_rcp_f32 v152, v152
    v_rcp_f32 v153, v153
    v_rcp_f32 v154, v154
    buffer_load_dwordx4 v[216:219], v5, s[20:23], s31 offen offset:2048 sc1
    v_rcp_f32 v155, v155
    v_rcp_f32 v156, v156
    v_rcp_f32 v157, v157
    v_rcp_f32 v158, v158
    v_rcp_f32_e64 v159, v159
    v_pk_mul_f32 v[144:145], v[144:145], v[112:113]
    v_pk_mul_f32 v[146:147], v[146:147], v[114:115]
    buffer_load_dwordx4 v[220:223], v5, s[20:23], s31 offen offset:3072 sc1
    v_pk_mul_f32 v[148:149], v[148:149], v[116:117]
    v_pk_mul_f32 v[150:151], v[150:151], v[118:119]
    v_pk_mul_f32 v[152:153], v[152:153], v[120:121]
    v_pk_mul_f32 v[154:155], v[154:155], v[122:123]
    v_pk_mul_f32 v[156:157], v[156:157], v[124:125]
    v_pk_mul_f32 v[158:159], v[158:159], v[126:127]
    v_cvt_pk_bf16_f32 v104, v144, v145
    v_cvt_pk_bf16_f32 v105, v146, v147
    v_cvt_pk_bf16_f32 v106, v148, v149
    v_cvt_pk_bf16_f32 v107, v150, v151
    v_cvt_pk_bf16_f32 v108, v152, v153
    v_cvt_pk_bf16_f32 v109, v154, v155
    v_cvt_pk_bf16_f32 v110, v156, v157
    v_cvt_pk_bf16_f32 v111, v158, v159
    buffer_store_dwordx4 v[104:107], v2, s[20:23], s62 offen offset:2048 sc1
    buffer_store_dwordx4 v[108:111], v2, s[20:23], s62 offen offset:3072 sc1
L_JOIN1:
    s_waitcnt lgkmcnt(0)
    s_barrier
    v_add_u32 v18, 73728, v20
    v_add_u32 v19, 73728, v21
    ds_read_b64_tr_b16 v[48:49], v18 offset:0
    ds_read_b64_tr_b16 v[50:51], v18 offset:512
    ds_read_b64_tr_b16 v[52:53], v19 offset:0
    ds_read_b64_tr_b16 v[54:55], v19 offset:512
    ds_read_b64_tr_b16 v[56:57], v18 offset:2048
    ds_read_b64_tr_b16 v[58:59], v18 offset:2560
    ds_read_b64_tr_b16 v[60:61], v19 offset:2048
    ds_read_b64_tr_b16 v[62:63], v19 offset:2560
    ds_read_b64_tr_b16 v[144:145], v18 offset:4096
    ds_read_b64_tr_b16 v[146:147], v18 offset:4608
    ds_read_b64_tr_b16 v[148:149], v19 offset:4096
    ds_read_b64_tr_b16 v[150:151], v19 offset:4608
    ds_read_b64_tr_b16 v[152:153], v18 offset:6144
    ds_read_b64_tr_b16 v[154:155], v18 offset:6656
    ds_read_b64_tr_b16 v[156:157], v19 offset:6144
    ds_read_b64_tr_b16 v[158:159], v19 offset:6656
    s_waitcnt lgkmcnt(0)
    s_barrier
    v_mfma_f32_32x32x16_bf16 v[32:47], v[128:131], v[224:227], v[32:47]
    v_add_u32 v18, 106496, v26
    v_add_u32 v19, 106496, v27
    ds_read_b64_tr_b16 v[112:113], v18 offset:0
    v_mfma_f32_32x32x16_bf16 v[80:95], v[132:135], v[224:227], v[80:95]
    ds_read_b64_tr_b16 v[114:115], v18 offset:1024
    ds_read_b64_tr_b16 v[116:117], v19 offset:0
    ds_read_b64_tr_b16 v[118:119], v19 offset:1024
    v_mfma_f32_32x32x16_bf16 v[32:47], v[136:139], v[228:231], v[32:47]
    ds_read_b64_tr_b16 v[120:121], v18 offset:2048
    ds_read_b64_tr_b16 v[122:123], v18 offset:3072
    ds_read_b64_tr_b16 v[124:125], v19 offset:2048
    v_mfma_f32_32x32x16_bf16 v[80:95], v[140:143], v[228:231], v[80:95]
    ds_read_b64_tr_b16 v[126:127], v19 offset:3072
    ds_read_b64_tr_b16 v[96:97], v18 offset:4096
    ds_read_b64_tr_b16 v[98:99], v18 offset:5120
    v_mfma_f32_32x32x16_bf16 v[32:47], v[64:67], v[232:235], v[32:47]
    ds_read_b64_tr_b16 v[100:101], v19 offset:4096
    ds_read_b64_tr_b16 v[102:103], v19 offset:5120
    ds_read_b64_tr_b16 v[104:105], v18 offset:6144
    v_mfma_f32_32x32x16_bf16 v[80:95], v[68:71], v[232:235], v[80:95]
    ds_read_b64_tr_b16 v[106:107], v18 offset:7168
    ds_read_b64_tr_b16 v[108:109], v19 offset:6144
    ds_read_b64_tr_b16 v[110:111], v19 offset:7168
    v_mfma_f32_32x32x16_bf16 v[32:47], v[72:75], v[236:239], v[32:47]
    v_mfma_f32_32x32x16_bf16 v[80:95], v[76:79], v[236:239], v[80:95]
    s_waitcnt lgkmcnt(0)
    s_barrier
    v_mfma_f32_32x32x16_bf16 v[32:47], v[48:51], v[240:243], v[32:47]
    v_add_u32 v18, 122880, v26
    v_add_u32 v19, 122880, v27
    ds_read_b64_tr_b16 v[128:129], v18 offset:0
    v_mfma_f32_32x32x16_bf16 v[80:95], v[52:55], v[240:243], v[80:95]
    ds_read_b64_tr_b16 v[130:131], v18 offset:1024
    ds_read_b64_tr_b16 v[132:133], v19 offset:0
    ds_read_b64_tr_b16 v[134:135], v19 offset:1024
    v_mfma_f32_32x32x16_bf16 v[32:47], v[56:59], v[244:247], v[32:47]
    ds_read_b64_tr_b16 v[136:137], v18 offset:2048
    ds_read_b64_tr_b16 v[138:139], v18 offset:3072
    ds_read_b64_tr_b16 v[140:141], v19 offset:2048
    v_mfma_f32_32x32x16_bf16 v[80:95], v[60:63], v[244:247], v[80:95]
    ds_read_b64_tr_b16 v[142:143], v19 offset:3072
    ds_read_b64_tr_b16 v[64:65], v18 offset:4096
    ds_read_b64_tr_b16 v[66:67], v18 offset:5120
    s_add_u32 s31, s67, s50
    s_nop 0
    buffer_load_dwordx4 v[224:227], v5, s[20:23], s31 offen offset:0 sc1
    v_mfma_f32_32x32x16_bf16 v[32:47], v[144:147], v[248:251], v[32:47]
    ds_read_b64_tr_b16 v[68:69], v19 offset:4096
    ds_read_b64_tr_b16 v[70:71], v19 offset:5120
    ds_read_b64_tr_b16 v[72:73], v18 offset:6144
    v_mfma_f32_32x32x16_bf16 v[80:95], v[148:151], v[248:251], v[80:95]
    ds_read_b64_tr_b16 v[74:75], v18 offset:7168
    ds_read_b64_tr_b16 v[76:77], v19 offset:6144
    buffer_load_dwordx4 v[228:231], v5, s[20:23], s31 offen offset:1024 sc1
    ds_read_b64_tr_b16 v[78:79], v19 offset:7168
    v_mfma_f32_32x32x16_bf16 v[32:47], v[152:155], v[252:255], v[32:47]
    v_mfma_f32_32x32x16_bf16 v[80:95], v[156:159], v[252:255], v[80:95]
    s_waitcnt lgkmcnt(0)
    s_barrier
    buffer_load_dwordx4 v[232:235], v5, s[20:23], s31 offen offset:2048 sc1
    s_waitcnt vmcnt(19)
    s_nop 0
    v_mfma_f32_32x32x16_bf16 v[32:47], v[112:115], v[160:163], v[32:47]
    v_add_u32 v18, 24576, v26
    v_add_u32 v19, 24576, v27
    ds_read_b64_tr_b16 v[48:49], v18 offset:0
    v_mfma_f32_32x32x16_bf16 v[80:95], v[116:119], v[160:163], v[80:95]
    buffer_load_dwordx4 v[236:239], v5, s[20:23], s31 offen offset:3072 sc1
    ds_read_b64_tr_b16 v[50:51], v18 offset:1024
    ds_read_b64_tr_b16 v[52:53], v19 offset:0
    ds_read_b64_tr_b16 v[54:55], v19 offset:1024
    v_mfma_f32_32x32x16_bf16 v[32:47], v[120:123], v[164:167], v[32:47]
    ds_read_b64_tr_b16 v[56:57], v18 offset:2048
    ds_read_b64_tr_b16 v[58:59], v18 offset:3072
    ds_read_b64_tr_b16 v[60:61], v19 offset:2048
    s_add_u32 s31, s68, s50
    s_nop 0
    buffer_load_dwordx4 v[240:243], v5, s[20:23], s31 offen offset:0 sc1
    v_mfma_f32_32x32x16_bf16 v[80:95], v[124:127], v[164:167], v[80:95]
    ds_read_b64_tr_b16 v[62:63], v19 offset:3072
    ds_read_b64_tr_b16 v[144:145], v18 offset:4096
    ds_read_b64_tr_b16 v[146:147], v18 offset:5120
    v_mfma_f32_32x32x16_bf16 v[32:47], v[96:99], v[168:171], v[32:47]
    buffer_load_dwordx4 v[244:247], v5, s[20:23], s31 offen offset:1024 sc1
    ds_read_b64_tr_b16 v[148:149], v19 offset:4096
    ds_read_b64_tr_b16 v[150:151], v19 offset:5120
    ds_read_b64_tr_b16 v[152:153], v18 offset:6144
    v_mfma_f32_32x32x16_bf16 v[80:95], v[100:103], v[168:171], v[80:95]
    ds_read_b64_tr_b16 v[154:155], v18 offset:7168
    ds_read_b64_tr_b16 v[156:157], v19 offset:6144
    ds_read_b64_tr_b16 v[158:159], v19 offset:7168
    buffer_load_dwordx4 v[248:251], v5, s[20:23], s31 offen offset:2048 sc1
    v_mfma_f32_32x32x16_bf16 v[32:47], v[104:107], v[172:175], v[32:47]
    v_mfma_f32_32x32x16_bf16 v[80:95], v[108:111], v[172:175], v[80:95]
    buffer_load_dwordx4 v[252:255], v5, s[20:23], s31 offen offset:3072 sc1
    s_waitcnt vmcnt(8)
    s_cmp_eq_u32 s45, 0
    s_cbranch_scc1 SAFE_24
    buffer_store_dword v15, v14, s[20:23], s57 offen offset:1024
STD_25:
    s_waitcnt lgkmcnt(0)
    s_barrier
    s_nop 0
    v_mfma_f32_32x32x16_bf16 v[32:47], v[128:131], v[176:179], v[32:47]
    v_add_u32 v18, 40960, v26
    v_add_u32 v19, 40960, v27
    ds_read_b64_tr_b16 v[112:113], v18 offset:0
    v_mfma_f32_32x32x16_bf16 v[80:95], v[132:135], v[176:179], v[80:95]
    s_add_u32 s31, s69, s50
    s_nop 0
    buffer_load_dwordx4 v[160:163], v5, s[20:23], s31 offen offset:0 sc1
    ds_read_b64_tr_b16 v[114:115], v18 offset:1024
    ds_read_b64_tr_b16 v[116:117], v19 offset:0
    ds_read_b64_tr_b16 v[118:119], v19 offset:1024
    v_mfma_f32_32x32x16_bf16 v[32:47], v[136:139], v[180:183], v[32:47]
    ds_read_b64_tr_b16 v[120:121], v18 offset:2048
    ds_read_b64_tr_b16 v[122:123], v18 offset:3072
    ds_read_b64_tr_b16 v[124:125], v19 offset:2048
    buffer_load_dwordx4 v[164:167], v5, s[20:23], s31 offen offset:1024 sc1
    v_mfma_f32_32x32x16_bf16 v[80:95], v[140:143], v[180:183], v[80:95]
    ds_read_b64_tr_b16 v[126:127], v19 offset:3072
    ds_read_b64_tr_b16 v[96:97], v18 offset:4096
    ds_read_b64_tr_b16 v[98:99], v18 offset:5120
    v_mfma_f32_32x32x16_bf16 v[32:47], v[64:67], v[184:187], v[32:47]
    buffer_load_dwordx4 v[168:171], v5, s[20:23], s31 offen offset:2048 sc1
    ds_read_b64_tr_b16 v[100:101], v19 offset:4096
    ds_read_b64_tr_b16 v[102:103], v19 offset:5120
    ds_read_b64_tr_b16 v[104:105], v18 offset:6144
    v_mfma_f32_32x32x16_bf16 v[80:95], v[68:71], v[184:187], v[80:95]
    ds_read_b64_tr_b16 v[106:107], v18 offset:7168
    ds_read_b64_tr_b16 v[108:109], v19 offset:6144
    ds_read_b64_tr_b16 v[110:111], v19 offset:7168
    buffer_load_dwordx4 v[172:175], v5, s[20:23], s31 offen offset:3072 sc1
    v_mfma_f32_32x32x16_bf16 v[32:47], v[72:75], v[188:191], v[32:47]
    v_mfma_f32_32x32x16_bf16 v[80:95], v[76:79], v[188:191], v[80:95]
    s_waitcnt lgkmcnt(0)
    s_barrier
    v_mfma_f32_32x32x16_bf16 v[32:47], v[48:51], v[192:195], v[32:47]
    v_add_u32 v18, 139264, v26
    v_add_u32 v19, 139264, v27
    ds_read_b64_tr_b16 v[128:129], v18 offset:0
    v_mfma_f32_32x32x16_bf16 v[80:95], v[52:55], v[192:195], v[80:95]
    ds_read_b64_tr_b16 v[130:131], v18 offset:1024
    ds_read_b64_tr_b16 v[132:133], v19 offset:0
    ds_read_b64_tr_b16 v[134:135], v19 offset:1024
    v_mfma_f32_32x32x16_bf16 v[32:47], v[56:59], v[196:199], v[32:47]
    ds_read_b64_tr_b16 v[136:137], v18 offset:2048
    ds_read_b64_tr_b16 v[138:139], v18 offset:3072
    ds_read_b64_tr_b16 v[140:141], v19 offset:2048
    v_mfma_f32_32x32x16_bf16 v[80:95], v[60:63], v[196:199], v[80:95]
    ds_read_b64_tr_b16 v[142:143], v19 offset:3072
    ds_read_b64_tr_b16 v[64:65], v18 offset:4096
    ds_read_b64_tr_b16 v[66:67], v18 offset:5120
    v_mfma_f32_32x32x16_bf16 v[32:47], v[144:147], v[200:203], v[32:47]
    ds_read_b64_tr_b16 v[68:69], v19 offset:4096
    ds_read_b64_tr_b16 v[70:71], v19 offset:5120
    ds_read_b64_tr_b16 v[72:73], v18 offset:6144
    v_mfma_f32_32x32x16_bf16 v[80:95], v[148:151], v[200:203], v[80:95]
    ds_read_b64_tr_b16 v[74:75], v18 offset:7168
    ds_read_b64_tr_b16 v[76:77], v19 offset:6144
    ds_read_b64_tr_b16 v[78:79], v19 offset:7168
    v_mfma_f32_32x32x16_bf16 v[32:47], v[152:155], v[204:207], v[32:47]
    v_mfma_f32_32x32x16_bf16 v[80:95], v[156:159], v[204:207], v[80:95]
    buffer_load_dword v16, v9, s[20:23], s60 offen offset:1024 sc1
    s_waitcnt lgkmcnt(0)
    s_barrier
    v_mfma_f32_32x32x16_bf16 v[32:47], v[112:115], v[208:211], v[32:47]
    v_add_u32 v18, 8192, v26
    v_add_u32 v19, 8192, v27
    ds_read_b64_tr_b16 v[48:49], v18 offset:0
    v_mfma_f32_32x32x16_bf16 v[80:95], v[116:119], v[208:211], v[80:95]
    ds_read_b64_tr_b16 v[50:51], v18 offset:1024
    ds_read_b64_tr_b16 v[52:53], v19 offset:0
    ds_read_b64_tr_b16 v[54:55], v19 offset:1024
    v_mfma_f32_32x32x16_bf16 v[32:47], v[120:123], v[212:215], v[32:47]
    ds_read_b64_tr_b16 v[56:57], v18 offset:2048
    ds_read_b64_tr_b16 v[58:59], v18 offset:3072
    ds_read_b64_tr_b16 v[60:61], v19 offset:2048
    v_mfma_f32_32x32x16_bf16 v[80:95], v[124:127], v[212:215], v[80:95]
    ds_read_b64_tr_b16 v[62:63], v19 offset:3072
    ds_read_b64_tr_b16 v[144:145], v18 offset:4096
    ds_read_b64_tr_b16 v[146:147], v18 offset:5120
    v_mfma_f32_32x32x16_bf16 v[32:47], v[96:99], v[216:219], v[32:47]
    ds_read_b64_tr_b16 v[148:149], v19 offset:4096
    ds_read_b64_tr_b16 v[150:151], v19 offset:5120
    ds_read_b64_tr_b16 v[152:153], v18 offset:6144
    v_mfma_f32_32x32x16_bf16 v[80:95], v[100:103], v[216:219], v[80:95]
    ds_read_b64_tr_b16 v[154:155], v18 offset:7168
    ds_read_b64_tr_b16 v[156:157], v19 offset:6144
    ds_read_b64_tr_b16 v[158:159], v19 offset:7168
    v_mfma_f32_32x32x16_bf16 v[32:47], v[104:107], v[220:223], v[32:47]
    v_mfma_f32_32x32x16_bf16 v[80:95], v[108:111], v[220:223], v[80:95]
    s_waitcnt lgkmcnt(0)
    s_barrier
    s_waitcnt vmcnt(10)
    s_nop 0
    v_mfma_f32_32x32x16_bf16 v[32:47], v[128:131], v[224:227], v[32:47]
    v_add_u32 v18, 90112, v26
    v_add_u32 v19, 90112, v27
    ds_read_b64_tr_b16 v[112:113], v18 offset:0
    v_mfma_f32_32x32x16_bf16 v[80:95], v[132:135], v[224:227], v[80:95]
    ds_read_b64_tr_b16 v[114:115], v18 offset:1024
    ds_read_b64_tr_b16 v[116:117], v19 offset:0
    ds_read_b64_tr_b16 v[118:119], v19 offset:1024
    v_mfma_f32_32x32x16_bf16 v[32:47], v[136:139], v[228:231], v[32:47]
    ds_read_b64_tr_b16 v[120:121], v18 offset:2048
    ds_read_b64_tr_b16 v[122:123], v18 offset:3072
    ds_read_b64_tr_b16 v[124:125], v19 offset:2048
    v_mfma_f32_32x32x16_bf16 v[80:95], v[140:143], v[228:231], v[80:95]
    ds_read_b64_tr_b16 v[126:127], v19 offset:3072
    ds_read_b64_tr_b16 v[96:97], v18 offset:4096
    ds_read_b64_tr_b16 v[98:99], v18 offset:5120
    v_mfma_f32_32x32x16_bf16 v[32:47], v[64:67], v[232:235], v[32:47]
    ds_read_b64_tr_b16 v[100:101], v19 offset:4096
    ds_read_b64_tr_b16 v[102:103], v19 offset:5120
    ds_read_b64_tr_b16 v[104:105], v18 offset:6144
    v_mfma_f32_32x32x16_bf16 v[80:95], v[68:71], v[232:235], v[80:95]
    ds_read_b64_tr_b16 v[106:107], v18 offset:7168
    ds_read_b64_tr_b16 v[108:109], v19 offset:6144
    ds_read_b64_tr_b16 v[110:111], v19 offset:7168
    v_mfma_f32_32x32x16_bf16 v[32:47], v[72:75], v[236:239], v[32:47]
    v_mfma_f32_32x32x16_bf16 v[80:95], v[76:79], v[236:239], v[80:95]
    s_waitcnt vmcnt(0)
SPIN_26:
    v_cmp_ne_u32_e64 vcc, 1, v16
    s_nop 0
    s_cbranch_vccnz RETRY_27
DONE_28:
    s_waitcnt lgkmcnt(0)
    s_barrier
    s_add_u32 s31, s63, s52
    buffer_load_dwordx4 v[176:179], v5, s[20:23], s31 offen offset:0 sc1
    v_mfma_f32_32x32x16_bf16 v[32:47], v[48:51], v[240:243], v[32:47]
    v_add_u32 v18, 57344, v26
    v_add_u32 v19, 57344, v27
    ds_read_b64_tr_b16 v[128:129], v18 offset:0
    v_mfma_f32_32x32x16_bf16 v[80:95], v[52:55], v[240:243], v[80:95]
    buffer_load_dwordx4 v[180:183], v5, s[20:23], s31 offen offset:1024 sc1
    ds_read_b64_tr_b16 v[130:131], v18 offset:1024
    ds_read_b64_tr_b16 v[132:133], v19 offset:0
    ds_read_b64_tr_b16 v[134:135], v19 offset:1024
    v_mfma_f32_32x32x16_bf16 v[32:47], v[56:59], v[244:247], v[32:47]
    ds_read_b64_tr_b16 v[136:137], v18 offset:2048
    ds_read_b64_tr_b16 v[138:139], v18 offset:3072
    ds_read_b64_tr_b16 v[140:141], v19 offset:2048
    buffer_load_dwordx4 v[184:187], v5, s[20:23], s31 offen offset:2048 sc1
    v_mfma_f32_32x32x16_bf16 v[80:95], v[60:63], v[244:247], v[80:95]
    ds_read_b64_tr_b16 v[142:143], v19 offset:3072
    ds_read_b64_tr_b16 v[64:65], v18 offset:4096
    ds_read_b64_tr_b16 v[66:67], v18 offset:5120
    v_mfma_f32_32x32x16_bf16 v[32:47], v[144:147], v[248:251], v[32:47]
    buffer_load_dwordx4 v[188:191], v5, s[20:23], s31 offen offset:3072 sc1
    ds_read_b64_tr_b16 v[68:69], v19 offset:4096
    ds_read_b64_tr_b16 v[70:71], v19 offset:5120
    ds_read_b64_tr_b16 v[72:73], v18 offset:6144
    v_mfma_f32_32x32x16_bf16 v[80:95], v[148:151], v[248:251], v[80:95]
    ds_read_b64_tr_b16 v[74:75], v18 offset:7168
    ds_read_b64_tr_b16 v[76:77], v19 offset:6144
    ds_read_b64_tr_b16 v[78:79], v19 offset:7168
    s_add_u32 s31, s64, s52
    s_nop 0
    buffer_load_dwordx4 v[192:195], v5, s[20:23], s31 offen offset:0 sc1
    v_mfma_f32_32x32x16_bf16 v[32:47], v[152:155], v[252:255], v[32:47]
    v_mfma_f32_32x32x16_bf16 v[80:95], v[156:159], v[252:255], v[80:95]
    buffer_load_dwordx4 v[196:199], v5, s[20:23], s31 offen offset:1024 sc1
    s_waitcnt lgkmcnt(0)
    s_barrier
    v_mfma_f32_32x32x16_bf16 v[32:47], v[112:115], v[160:163], v[32:47]
    v_add_u32 v18, 73728, v26
    v_add_u32 v19, 73728, v27
    ds_read_b64_tr_b16 v[48:49], v18 offset:0
    v_mfma_f32_32x32x16_bf16 v[80:95], v[116:119], v[160:163], v[80:95]
    buffer_load_dwordx4 v[200:203], v5, s[20:23], s31 offen offset:2048 sc1
    ds_read_b64_tr_b16 v[50:51], v18 offset:1024
    ds_read_b64_tr_b16 v[52:53], v19 offset:0
    ds_read_b64_tr_b16 v[54:55], v19 offset:1024
    v_mfma_f32_32x32x16_bf16 v[32:47], v[120:123], v[164:167], v[32:47]
    ds_read_b64_tr_b16 v[56:57], v18 offset:2048
    ds_read_b64_tr_b16 v[58:59], v18 offset:3072
    ds_read_b64_tr_b16 v[60:61], v19 offset:2048
    buffer_load_dwordx4 v[204:207], v5, s[20:23], s31 offen offset:3072 sc1
    v_mfma_f32_32x32x16_bf16 v[80:95], v[124:127], v[164:167], v[80:95]
    ds_read_b64_tr_b16 v[62:63], v19 offset:3072
    ds_read_b64_tr_b16 v[144:145], v18 offset:4096
    ds_read_b64_tr_b16 v[146:147], v18 offset:5120
    v_mfma_f32_32x32x16_bf16 v[32:47], v[96:99], v[168:171], v[32:47]
    s_add_u32 s31, s65, s52
    s_nop 0
    buffer_load_dwordx4 v[208:211], v5, s[20:23], s31 offen offset:0 sc1
    ds_read_b64_tr_b16 v[148:149], v19 offset:4096
    ds_read_b64_tr_b16 v[150:151], v19 offset:5120
    ds_read_b64_tr_b16 v[152:153], v18 offset:6144
    v_mfma_f32_32x32x16_bf16 v[80:95], v[100:103], v[168:171], v[80:95]
    ds_read_b64_tr_b16 v[154:155], v18 offset:7168
    ds_read_b64_tr_b16 v[156:157], v19 offset:6144
    ds_read_b64_tr_b16 v[158:159], v19 offset:7168
    buffer_load_dwordx4 v[212:215], v5, s[20:23], s31 offen offset:1024 sc1
    v_mfma_f32_32x32x16_bf16 v[32:47], v[104:107], v[172:175], v[32:47]
    v_mfma_f32_32x32x16_bf16 v[80:95], v[108:111], v[172:175], v[80:95]
    buffer_load_dwordx4 v[216:219], v5, s[20:23], s31 offen offset:2048 sc1
    s_waitcnt lgkmcnt(0)
    s_barrier
    buffer_load_dwordx4 v[220:223], v5, s[20:23], s31 offen offset:3072 sc1
    s_add_u32 s31, s66, s52
    buffer_load_dwordx4 v[224:227], v5, s[20:23], s31 offen offset:0 sc1
    buffer_load_dwordx4 v[228:231], v5, s[20:23], s31 offen offset:1024 sc1
    s_waitcnt vmcnt(10)
    v_mfma_f32_32x32x16_bf16 v[32:47], v[128:131], v[176:179], v[32:47]
    v_add_u32 v18, 106496, v26
    v_add_u32 v19, 106496, v27
    ds_read_b64_tr_b16 v[112:113], v18 offset:0
    v_mfma_f32_32x32x16_bf16 v[80:95], v[132:135], v[176:179], v[80:95]
    buffer_load_dwordx4 v[232:235], v5, s[20:23], s31 offen offset:2048 sc1
    ds_read_b64_tr_b16 v[114:115], v18 offset:1024
    ds_read_b64_tr_b16 v[116:117], v19 offset:0
    ds_read_b64_tr_b16 v[118:119], v19 offset:1024
    v_mfma_f32_32x32x16_bf16 v[32:47], v[136:139], v[180:183], v[32:47]
    ds_read_b64_tr_b16 v[120:121], v18 offset:2048
    ds_read_b64_tr_b16 v[122:123], v18 offset:3072
    ds_read_b64_tr_b16 v[124:125], v19 offset:2048
    buffer_load_dwordx4 v[236:239], v5, s[20:23], s31 offen offset:3072 sc1
    v_mfma_f32_32x32x16_bf16 v[80:95], v[140:143], v[180:183], v[80:95]
    ds_read_b64_tr_b16 v[126:127], v19 offset:3072
    ds_read_b64_tr_b16 v[96:97], v18 offset:4096
    ds_read_b64_tr_b16 v[98:99], v18 offset:5120
    v_mfma_f32_32x32x16_bf16 v[32:47], v[64:67], v[184:187], v[32:47]
    ds_read_b64_tr_b16 v[100:101], v19 offset:4096
    ds_read_b64_tr_b16 v[102:103], v19 offset:5120
    ds_read_b64_tr_b16 v[104:105], v18 offset:6144
    v_mfma_f32_32x32x16_bf16 v[80:95], v[68:71], v[184:187], v[80:95]
    ds_read_b64_tr_b16 v[106:107], v18 offset:7168
    ds_read_b64_tr_b16 v[108:109], v19 offset:6144
    ds_read_b64_tr_b16 v[110:111], v19 offset:7168
    v_mfma_f32_32x32x16_bf16 v[32:47], v[72:75], v[188:191], v[32:47]
    v_mfma_f32_32x32x16_bf16 v[80:95], v[76:79], v[188:191], v[80:95]
    s_waitcnt lgkmcnt(0)
    s_barrier
    s_waitcnt vmcnt(8)
    s_nop 0
    v_mfma_f32_32x32x16_bf16 v[32:47], v[48:51], v[192:195], v[32:47]
    v_add_u32 v18, 122880, v26
    v_add_u32 v19, 122880, v27
    ds_read_b64_tr_b16 v[128:129], v18 offset:0
    v_mfma_f32_32x32x16_bf16 v[80:95], v[52:55], v[192:195], v[80:95]
    ds_read_b64_tr_b16 v[130:131], v18 offset:1024
    ds_read_b64_tr_b16 v[132:133], v19 offset:0
    ds_read_b64_tr_b16 v[134:135], v19 offset:1024
    v_mfma_f32_32x32x16_bf16 v[32:47], v[56:59], v[196:199], v[32:47]
    s_add_u32 s31, s67, s52
    s_nop 0
    buffer_load_dwordx4 v[240:243], v5, s[20:23], s31 offen offset:0 sc1
    ds_read_b64_tr_b16 v[136:137], v18 offset:2048
    ds_read_b64_tr_b16 v[138:139], v18 offset:3072
    ds_read_b64_tr_b16 v[140:141], v19 offset:2048
    v_mfma_f32_32x32x16_bf16 v[80:95], v[60:63], v[196:199], v[80:95]
    ds_read_b64_tr_b16 v[142:143], v19 offset:3072
    ds_read_b64_tr_b16 v[64:65], v18 offset:4096
    ds_read_b64_tr_b16 v[66:67], v18 offset:5120
    buffer_load_dwordx4 v[244:247], v5, s[20:23], s31 offen offset:1024 sc1
    v_mfma_f32_32x32x16_bf16 v[32:47], v[144:147], v[200:203], v[32:47]
    ds_read_b64_tr_b16 v[68:69], v19 offset:4096
    ds_read_b64_tr_b16 v[70:71], v19 offset:5120
    ds_read_b64_tr_b16 v[72:73], v18 offset:6144
    v_mfma_f32_32x32x16_bf16 v[80:95], v[148:151], v[200:203], v[80:95]
    buffer_load_dwordx4 v[248:251], v5, s[20:23], s31 offen offset:2048 sc1
    ds_read_b64_tr_b16 v[74:75], v18 offset:7168
    ds_read_b64_tr_b16 v[76:77], v19 offset:6144
    ds_read_b64_tr_b16 v[78:79], v19 offset:7168
    v_mfma_f32_32x32x16_bf16 v[32:47], v[152:155], v[204:207], v[32:47]
    v_mfma_f32_32x32x16_bf16 v[80:95], v[156:159], v[204:207], v[80:95]
    buffer_load_dwordx4 v[252:255], v5, s[20:23], s31 offen offset:3072 sc1
    s_waitcnt lgkmcnt(0)
    s_barrier
    s_waitcnt vmcnt(8)
    s_nop 0
    v_mfma_f32_32x32x16_bf16 v[32:47], v[112:115], v[208:211], v[32:47]
    v_add_u32 v18, 24576, v26
    v_add_u32 v19, 24576, v27
    ds_read_b64_tr_b16 v[48:49], v18 offset:0
    v_mfma_f32_32x32x16_bf16 v[80:95], v[116:119], v[208:211], v[80:95]
    s_add_u32 s31, s68, s52
    s_nop 0
    buffer_load_dwordx4 v[160:163], v5, s[20:23], s31 offen offset:0 sc1
    ds_read_b64_tr_b16 v[50:51], v18 offset:1024
    ds_read_b64_tr_b16 v[52:53], v19 offset:0
    ds_read_b64_tr_b16 v[54:55], v19 offset:1024
    v_mfma_f32_32x32x16_bf16 v[32:47], v[120:123], v[212:215], v[32:47]
    ds_read_b64_tr_b16 v[56:57], v18 offset:2048
    ds_read_b64_tr_b16 v[58:59], v18 offset:3072
    ds_read_b64_tr_b16 v[60:61], v19 offset:2048
    buffer_load_dwordx4 v[164:167], v5, s[20:23], s31 offen offset:1024 sc1
    v_mfma_f32_32x32x16_bf16 v[80:95], v[124:127], v[212:215], v[80:95]
    ds_read_b64_tr_b16 v[62:63], v19 offset:3072
    ds_read_b64_tr_b16 v[144:145], v18 offset:4096
    ds_read_b64_tr_b16 v[146:147], v18 offset:5120
    v_mfma_f32_32x32x16_bf16 v[32:47], v[96:99], v[216:219], v[32:47]
    buffer_load_dwordx4 v[168:171], v5, s[20:23], s31 offen offset:2048 sc1
    ds_read_b64_tr_b16 v[148:149], v19 offset:4096
    ds_read_b64_tr_b16 v[150:151], v19 offset:5120
    ds_read_b64_tr_b16 v[152:153], v18 offset:6144
    v_mfma_f32_32x32x16_bf16 v[80:95], v[100:103], v[216:219], v[80:95]
    ds_read_b64_tr_b16 v[154:155], v18 offset:7168
    ds_read_b64_tr_b16 v[156:157], v19 offset:6144
    ds_read_b64_tr_b16 v[158:159], v19 offset:7168
    buffer_load_dwordx4 v[172:175], v5, s[20:23], s31 offen offset:3072 sc1
    v_mfma_f32_32x32x16_bf16 v[32:47], v[104:107], v[220:223], v[32:47]
    v_mfma_f32_32x32x16_bf16 v[80:95], v[108:111], v[220:223], v[80:95]
    s_add_u32 s31, s69, s52
    buffer_load_dwordx4 v[176:179], v5, s[20:23], s31 offen offset:0 sc1
    s_waitcnt lgkmcnt(0)
    s_barrier
    s_waitcnt vmcnt(9)
    v_mfma_f32_32x32x16_bf16 v[32:47], v[128:131], v[224:227], v[32:47]
    v_add_u32 v18, 40960, v26
    v_add_u32 v19, 40960, v27
    ds_read_b64_tr_b16 v[112:113], v18 offset:0
    v_mfma_f32_32x32x16_bf16 v[80:95], v[132:135], v[224:227], v[80:95]
    buffer_load_dwordx4 v[180:183], v5, s[20:23], s31 offen offset:1024 sc1
    ds_read_b64_tr_b16 v[114:115], v18 offset:1024
    ds_read_b64_tr_b16 v[116:117], v19 offset:0
    ds_read_b64_tr_b16 v[118:119], v19 offset:1024
    v_mfma_f32_32x32x16_bf16 v[32:47], v[136:139], v[228:231], v[32:47]
    ds_read_b64_tr_b16 v[120:121], v18 offset:2048
    ds_read_b64_tr_b16 v[122:123], v18 offset:3072
    ds_read_b64_tr_b16 v[124:125], v19 offset:2048
    buffer_load_dwordx4 v[184:187], v5, s[20:23], s31 offen offset:2048 sc1
    v_mfma_f32_32x32x16_bf16 v[80:95], v[140:143], v[228:231], v[80:95]
    ds_read_b64_tr_b16 v[126:127], v19 offset:3072
    ds_read_b64_tr_b16 v[96:97], v18 offset:4096
    ds_read_b64_tr_b16 v[98:99], v18 offset:5120
    v_mfma_f32_32x32x16_bf16 v[32:47], v[64:67], v[232:235], v[32:47]
    buffer_load_dwordx4 v[188:191], v5, s[20:23], s31 offen offset:3072 sc1
    ds_read_b64_tr_b16 v[100:101], v19 offset:4096
    ds_read_b64_tr_b16 v[102:103], v19 offset:5120
    ds_read_b64_tr_b16 v[104:105], v18 offset:6144
    v_mfma_f32_32x32x16_bf16 v[80:95], v[68:71], v[232:235], v[80:95]
    ds_read_b64_tr_b16 v[106:107], v18 offset:7168
    ds_read_b64_tr_b16 v[108:109], v19 offset:6144
    ds_read_b64_tr_b16 v[110:111], v19 offset:7168
    v_mfma_f32_32x32x16_bf16 v[32:47], v[72:75], v[236:239], v[32:47]
    v_mfma_f32_32x32x16_bf16 v[80:95], v[76:79], v[236:239], v[80:95]
    s_waitcnt lgkmcnt(0)
    s_barrier
    s_waitcnt vmcnt(8)
    s_nop 0
    v_mfma_f32_32x32x16_bf16 v[32:47], v[48:51], v[240:243], v[32:47]
    v_add_u32 v18, 139264, v26
    v_add_u32 v19, 139264, v27
    ds_read_b64_tr_b16 v[128:129], v18 offset:0
    v_mfma_f32_32x32x16_bf16 v[80:95], v[52:55], v[240:243], v[80:95]
    ds_read_b64_tr_b16 v[130:131], v18 offset:1024
    ds_read_b64_tr_b16 v[132:133], v19 offset:0
    ds_read_b64_tr_b16 v[134:135], v19 offset:1024
    v_mfma_f32_32x32x16_bf16 v[32:47], v[56:59], v[244:247], v[32:47]
    ds_read_b64_tr_b16 v[136:137], v18 offset:2048
    ds_read_b64_tr_b16 v[138:139], v18 offset:3072
    ds_read_b64_tr_b16 v[140:141], v19 offset:2048
    v_mfma_f32_32x32x16_bf16 v[80:95], v[60:63], v[244:247], v[80:95]
    ds_read_b64_tr_b16 v[142:143], v19 offset:3072
    ds_read_b64_tr_b16 v[64:65], v18 offset:4096
    ds_read_b64_tr_b16 v[66:67], v18 offset:5120
    v_mfma_f32_32x32x16_bf16 v[32:47], v[144:147], v[248:251], v[32:47]
    ds_read_b64_tr_b16 v[68:69], v19 offset:4096
    ds_read_b64_tr_b16 v[70:71], v19 offset:5120
    ds_read_b64_tr_b16 v[72:73], v18 offset:6144
    v_mfma_f32_32x32x16_bf16 v[80:95], v[148:151], v[248:251], v[80:95]
    ds_read_b64_tr_b16 v[74:75], v18 offset:7168
    ds_read_b64_tr_b16 v[76:77], v19 offset:6144
    ds_read_b64_tr_b16 v[78:79], v19 offset:7168
    v_mfma_f32_32x32x16_bf16 v[32:47], v[152:155], v[252:255], v[32:47]
    v_mfma_f32_32x32x16_bf16 v[80:95], v[156:159], v[252:255], v[80:95]
    s_waitcnt vmcnt(4)
    v_and_b32 v8, 31, v4
    v_lshrrev_b32 v10, 5, v4
    v_lshlrev_b32 v8, 10, v8
    v_lshl_add_u32 v8, v10, 4, v8
    s_lshl_b32 s27, s46, 15
    s_lshl1_add_u32 s26, s40, s18
    s_lshl_b32 s26, s26, 6
    s_add_u32 s27, s27, s26
    v_mfma_f32_32x32x16_bf16 v[32:47], v[112:115], v[160:163], v[32:47]
    v_mfma_f32_32x32x16_bf16 v[80:95], v[116:119], v[160:163], v[80:95]
    v_mfma_f32_32x32x16_bf16 v[32:47], v[120:123], v[164:167], v[32:47]
    v_mfma_f32_32x32x16_bf16 v[80:95], v[124:127], v[164:167], v[80:95]
    v_mfma_f32_32x32x16_bf16 v[32:47], v[96:99], v[168:171], v[32:47]
    v_mfma_f32_32x32x16_bf16 v[80:95], v[100:103], v[168:171], v[80:95]
    v_mfma_f32_32x32x16_bf16 v[32:47], v[104:107], v[172:175], v[32:47]
    v_mfma_f32_32x32x16_bf16 v[80:95], v[108:111], v[172:175], v[80:95]
    s_waitcnt lgkmcnt(0)
    s_waitcnt vmcnt(0)
    v_mfma_f32_32x32x16_bf16 v[80:95], v[132:135], v[176:179], v[80:95]
    v_mfma_f32_32x32x16_bf16 v[80:95], v[140:143], v[180:183], v[80:95]
    v_mfma_f32_32x32x16_bf16 v[80:95], v[68:71], v[184:187], v[80:95]
    v_mfma_f32_32x32x16_bf16 v[80:95], v[76:79], v[188:191], v[80:95]
    v_mfma_f32_32x32x16_bf16 v[32:47], v[128:131], v[176:179], v[32:47]
    s_add_u32 s25, s32, 73728
    v_add_u32_e64 v6, s25, v5
    s_xor_b32 s25, s32, 8192
    s_add_u32 s25, s25, 73728
    v_add_u32_e64 v7, s25, v5
    v_mfma_f32_32x32x16_bf16 v[32:47], v[136:139], v[180:183], v[32:47]
    v_mfma_f32_32x32x16_bf16 v[32:47], v[64:67], v[184:187], v[32:47]
    s_nop 2
    s_nop 0
    ds_write_b128 v6, v[80:83] offset:0
    ds_write_b128 v6, v[84:87] offset:1024
    v_mfma_f32_32x32x16_bf16 v[32:47], v[72:75], v[188:191], v[32:47]
    ds_write_b128 v6, v[88:91] offset:2048
    ds_write_b128 v6, v[92:95] offset:3072
    s_waitcnt lgkmcnt(0)
    s_barrier
    ds_read_b128 v[80:83], v7 offset:0
    ds_read_b128 v[84:87], v7 offset:1024
    ds_read_b128 v[88:91], v7 offset:2048
    ds_read_b128 v[92:95], v7 offset:3072
    s_waitcnt lgkmcnt(3)
    s_nop 2
    v_pk_add_f32 v[32:33], v[32:33], v[80:81]
    v_pk_add_f32 v[34:35], v[34:35], v[82:83]
    s_waitcnt lgkmcnt(2)
    v_pk_add_f32 v[36:37], v[36:37], v[84:85]
    v_pk_add_f32 v[38:39], v[38:39], v[86:87]
    s_waitcnt lgkmcnt(1)
    v_pk_add_f32 v[40:41], v[40:41], v[88:89]
    v_pk_add_f32 v[42:43], v[42:43], v[90:91]
    s_waitcnt lgkmcnt(0)
    s_nop 0
    v_pk_add_f32 v[44:45], v[44:45], v[92:93]
    v_pk_add_f32 v[46:47], v[46:47], v[94:95]
    v_cvt_pk_bf16_f32 v112, v32, v33
    v_cvt_pk_bf16_f32 v113, v34, v35
    v_cvt_pk_bf16_f32 v114, v36, v37
    v_cvt_pk_bf16_f32 v115, v38, v39
    v_cvt_pk_bf16_f32 v116, v40, v41
    v_cvt_pk_bf16_f32 v117, v42, v43
    v_cvt_pk_bf16_f32 v118, v44, v45
    v_cvt_pk_bf16_f32 v119, v46, v47
    v_permlane32_swap_b32 v112, v114
    v_permlane32_swap_b32 v113, v115
    v_permlane32_swap_b32 v116, v118
    v_permlane32_swap_b32 v117, v119
    buffer_store_dwordx4 v[112:115], v8, s[8:11], s27 offen offset:0
    buffer_store_dwordx4 v[116:119], v8, s[8:11], s27 offen offset:32
L_END:
    s_endpgm
ARETRY_1:
    s_mov_b32 s28, 20
ARETRY_1_L:
    buffer_load_dword v16, v17, s[12:15], s5 offen sc1
    s_waitcnt vmcnt(0)
    v_cmp_ne_u32 vcc, s4, v16
    s_nop 1
    s_cbranch_vccz ADONE_3
    s_sub_u32 s28, s28, 1
    s_cbranch_scc0 ARETRY_1_L
    s_mov_b32 s45, 0
    v_mov_b32 v10, 0
ASAFE_2:
    buffer_load_dword v16, v10, s[12:15], s17 offen offset:128 sc1
    s_waitcnt vmcnt(0)
    v_cmp_ne_u32 vcc, 1, v16
    s_nop 1
    s_cbranch_vccz ADONE_3
    s_sub_u32 s29, s29, 1
    s_cbranch_scc0 ASAFE_2
    s_mov_b32 s29, 0
    s_branch ADONE_3
SAFE_4:
    buffer_store_dword v15, v14, s[20:23], s55 offen offset:0 sc1
    s_branch STD_5
RETRY_7:
    buffer_load_dword v16, v0, s[20:23], s58 offen offset:0 sc1
    s_waitcnt vmcnt(0)
    s_sub_u32 s29, s29, 1
    s_cbranch_scc0 SPIN_6
    s_mov_b32 s29, 0
    s_branch DONE_8
SAFE_9:
    buffer_store_dword v15, v14, s[20:23], s56 offen offset:512 sc1
    s_branch STD_10
RETRY_12:
    buffer_load_dword v16, v0, s[20:23], s59 offen offset:512 sc1
    s_waitcnt vmcnt(0)
    s_sub_u32 s29, s29, 1
    s_cbranch_scc0 SPIN_11
    s_mov_b32 s29, 0
    s_branch DONE_13
SAFE_14:
    buffer_store_dword v15, v14, s[20:23], s55 offen offset:256 sc1
    s_branch STD_15
RETRY_17:
    buffer_load_dword v16, v0, s[20:23], s58 offen offset:256 sc1
    s_waitcnt vmcnt(0)
    s_sub_u32 s29, s29, 1
    s_cbranch_scc0 SPIN_16
    s_mov_b32 s29, 0
    s_branch DONE_18
SAFE_19:
    buffer_store_dword v15, v14, s[20:23], s57 offen offset:768 sc1
    s_branch STD_20
L_IDLE0:
    s_nop 0
    v_add_u32 v18, 90112, v26
    v_add_u32 v19, 90112, v27
    v_add_u32 v28, 57344, v26
    v_add_u32 v29, 57344, v27
    s_waitcnt vmcnt(0)
SPIN_11_I:
    v_cmp_ne_u32 vcc, 1, v16
    s_nop 0
DONE_13_I:
    s_xor_b32 s31, s49, 0
    s_xor_b32 s31, s49, 4096
    s_xor_b32 s31, s49, 8192
    s_waitcnt vmcnt(0)
    s_xor_b32 s31, s49, 12288
    s_waitcnt vmcnt(0)
    s_xor_b32 s31, s49, 16384
    s_waitcnt vmcnt(0)
    s_nop 0
    s_xor_b32 s31, s49, 20480
    v_add_u32 v18, 73728, v26
    v_add_u32 v19, 73728, v27
    v_add_u32 v28, 106496, v26
    v_add_u32 v29, 106496, v27
    s_xor_b32 s31, s49, 24576
    s_barrier
    s_cmp_eq_u32 s45, 0
    s_cbranch_scc1 SAFE_14_I
    buffer_store_dword v15, v14, s[20:23], s55 offen offset:256
STD_15_I:
    s_waitcnt vmcnt(0)
    s_xor_b32 s31, s49, 28672
    s_waitcnt vmcnt(0)
    v_add_u32 v18, 122880, v26
    v_add_u32 v19, 122880, v27
    s_barrier
    buffer_load_dword v16, v0, s[20:23], s58 offen offset:256 sc1
    s_waitcnt vmcnt(0)
SPIN_16_I:
    v_cmp_ne_u32 vcc, 1, v16
    s_nop 0
    s_cbranch_vccnz RETRY_17_I
DONE_18_I:
    v_add_u32 v18, 24576, v26
    v_add_u32 v19, 24576, v27
    s_xor_b32 s31, s48, 2097152
    buffer_load_dwordx4 v[192:195], v5, s[20:23], s31 offen offset:0 sc1
    s_barrier
    s_nop 0
    buffer_load_dwordx4 v[196:199], v5, s[20:23], s31 offen offset:1024 sc1
    buffer_load_dwordx4 v[200:203], v5, s[20:23], s31 offen offset:2048 sc1
    buffer_load_dwordx4 v[204:207], v5, s[20:23], s31 offen offset:3072 sc1
    s_xor_b32 s31, s48, 2101248
    buffer_load_dwordx4 v[208:211], v5, s[20:23], s31 offen offset:0 sc1
    buffer_load_dwordx4 v[212:215], v5, s[20:23], s31 offen offset:1024 sc1
    buffer_load_dwordx4 v[216:219], v5, s[20:23], s31 offen offset:2048 sc1
    buffer_load_dwordx4 v[220:223], v5, s[20:23], s31 offen offset:3072 sc1
    s_lshl_b32 s26, s43, 10
    s_addk_i32 s26, 3328
    v_add_u32 v6, s26, v5
    s_barrier
    v_add_u32 v28, 40960, v26
    v_add_u32 v29, 40960, v27
    s_xor_b32 s31, s48, 2105344
    buffer_load_dwordx4 v[224:227], v5, s[20:23], s31 offen offset:0 sc1
    v_add_u32 v28, 139264, v26
    v_add_u32 v29, 139264, v27
    buffer_load_dwordx4 v[228:231], v5, s[20:23], s31 offen offset:1024 sc1
    s_barrier
    s_nop 0
    buffer_load_dwordx4 v[232:235], v5, s[20:23], s31 offen offset:2048 sc1
    buffer_load_dwordx4 v[236:239], v5, s[20:23], s31 offen offset:3072 sc1
    s_xor_b32 s31, s48, 2109440
    buffer_load_dwordx4 v[240:243], v5, s[20:23], s31 offen offset:0 sc1
    buffer_load_dwordx4 v[244:247], v5, s[20:23], s31 offen offset:1024 sc1
    buffer_load_dwordx4 v[248:251], v5, s[20:23], s31 offen offset:2048 sc1
    buffer_load_dwordx4 v[252:255], v5, s[20:23], s31 offen offset:3072 sc1
    s_waitcnt vmcnt(0)
    s_cmp_eq_u32 s45, 0
    s_cbranch_scc1 SAFE_19_I
    buffer_store_dword v15, v14, s[20:23], s57 offen offset:768
STD_20_I:
    s_barrier
    v_add_u32 v18, 8192, v20
    v_add_u32 v19, 8192, v21
    ds_read_b64_tr_b16 v[128:129], v18 offset:0
    ds_read_b64_tr_b16 v[130:131], v18 offset:512
    ds_read_b64_tr_b16 v[132:133], v19 offset:0
    ds_read_b64_tr_b16 v[134:135], v19 offset:512
    ds_read_b64_tr_b16 v[136:137], v18 offset:2048
    ds_read_b64_tr_b16 v[138:139], v18 offset:2560
    ds_read_b64_tr_b16 v[140:141], v19 offset:2048
    ds_read_b64_tr_b16 v[142:143], v19 offset:2560
    s_barrier
    s_nop 0
    ds_read_b64_tr_b16 v[48:49], v18 offset:4096
    ds_read_b64_tr_b16 v[50:51], v18 offset:4608
    ds_read_b64_tr_b16 v[52:53], v19 offset:4096
    ds_read_b64_tr_b16 v[54:55], v19 offset:4608
    ds_read_b64_tr_b16 v[56:57], v18 offset:6144
    ds_read_b64_tr_b16 v[58:59], v18 offset:6656
    ds_read_b64_tr_b16 v[60:61], v19 offset:6144
    ds_read_b64_tr_b16 v[62:63], v19 offset:6656
    s_waitcnt vmcnt(0) lgkmcnt(0)
    s_nop 14
    s_nop 0
    s_branch L_JOIN0
RETRY_12_I:
    buffer_load_dword v16, v0, s[20:23], s59 offen offset:512 sc1
    s_waitcnt vmcnt(0)
    s_sub_u32 s29, s29, 1
    s_cbranch_scc0 SPIN_11_I
    s_mov_b32 s29, 0
    s_branch DONE_13_I
SAFE_14_I:
    buffer_store_dword v15, v14, s[20:23], s55 offen offset:256 sc1
    s_branch STD_15_I
RETRY_17_I:
    buffer_load_dword v16, v0, s[20:23], s58 offen offset:256 sc1
    s_waitcnt vmcnt(0)
    s_sub_u32 s29, s29, 1
    s_cbranch_scc0 SPIN_16_I
    s_mov_b32 s29, 0
    s_branch DONE_18_I
SAFE_19_I:
    buffer_store_dword v15, v14, s[20:23], s57 offen offset:768 sc1
    s_branch STD_20_I
RETRY_22:
    buffer_load_dword v17, v9, s[20:23], s60 offen offset:768 sc1
    s_waitcnt vmcnt(0)
    s_sub_u32 s29, s29, 1
    s_cbranch_scc0 SPIN_21
    s_mov_b32 s29, 0
    s_branch DONE_23
L_IDLE1:
    s_mul_i32 s25, s18, 8256
    v_xor_b32 v26, s25, v26
    v_xor_b32 v27, 64, v26
    s_waitcnt vmcnt(0)
SPIN_21_I:
    v_cmp_ne_u32 vcc, 1, v17
    s_nop 0
    s_cbranch_vccnz RETRY_22_I
DONE_23_I:
    s_add_u32 s31, s63, s50
    buffer_load_dwordx4 v[160:163], v5, s[20:23], s31 offen offset:0 sc1
    buffer_load_dwordx4 v[164:167], v5, s[20:23], s31 offen offset:1024 sc1
    buffer_load_dwordx4 v[168:171], v5, s[20:23], s31 offen offset:2048 sc1
    buffer_load_dwordx4 v[172:175], v5, s[20:23], s31 offen offset:3072 sc1
    s_add_u32 s31, s64, s50
    buffer_load_dwordx4 v[176:179], v5, s[20:23], s31 offen offset:0 sc1
    s_addk_i32 s62, 4096
    buffer_load_dwordx4 v[180:183], v5, s[20:23], s31 offen offset:1024 sc1
    buffer_load_dwordx4 v[184:187], v5, s[20:23], s31 offen offset:2048 sc1
    buffer_load_dwordx4 v[188:191], v5, s[20:23], s31 offen offset:3072 sc1
    s_add_u32 s31, s65, s50
    buffer_load_dwordx4 v[192:195], v5, s[20:23], s31 offen offset:0 sc1
    buffer_load_dwordx4 v[196:199], v5, s[20:23], s31 offen offset:1024 sc1
    buffer_load_dwordx4 v[200:203], v5, s[20:23], s31 offen offset:2048 sc1
    s_barrier
    v_add_u32 v18, 57344, v20
    v_add_u32 v19, 57344, v21
    ds_read_b64_tr_b16 v[128:129], v18 offset:0
    ds_read_b64_tr_b16 v[130:131], v18 offset:512
    ds_read_b64_tr_b16 v[132:133], v19 offset:0
    ds_read_b64_tr_b16 v[134:135], v19 offset:512
    ds_read_b64_tr_b16 v[136:137], v18 offset:2048
    ds_read_b64_tr_b16 v[138:139], v18 offset:2560
    buffer_load_dwordx4 v[204:207], v5, s[20:23], s31 offen offset:3072 sc1
    ds_read_b64_tr_b16 v[140:141], v19 offset:2048
    ds_read_b64_tr_b16 v[142:143], v19 offset:2560
    ds_read_b64_tr_b16 v[64:65], v18 offset:4096
    ds_read_b64_tr_b16 v[66:67], v18 offset:4608
    ds_read_b64_tr_b16 v[68:69], v19 offset:4096
    ds_read_b64_tr_b16 v[70:71], v19 offset:4608
    ds_read_b64_tr_b16 v[72:73], v18 offset:6144
    ds_read_b64_tr_b16 v[74:75], v18 offset:6656
    s_add_u32 s31, s66, s50
    s_nop 0
    buffer_load_dwordx4 v[208:211], v5, s[20:23], s31 offen offset:0 sc1
    ds_read_b64_tr_b16 v[76:77], v19 offset:6144
    ds_read_b64_tr_b16 v[78:79], v19 offset:6656
    buffer_load_dwordx4 v[212:215], v5, s[20:23], s31 offen offset:1024 sc1
    buffer_load_dwordx4 v[216:219], v5, s[20:23], s31 offen offset:2048 sc1
    buffer_load_dwordx4 v[220:223], v5, s[20:23], s31 offen offset:3072 sc1
    s_waitcnt vmcnt(0) lgkmcnt(0)
    s_nop 14
    s_nop 0
    s_branch L_JOIN1
RETRY_22_I:
    buffer_load_dword v17, v9, s[20:23], s60 offen offset:768 sc1
    s_waitcnt vmcnt(0)
    s_sub_u32 s29, s29, 1
    s_cbranch_scc0 SPIN_21_I
    s_mov_b32 s29, 0
    s_branch DONE_23_I
SAFE_24:
    buffer_store_dword v15, v14, s[20:23], s57 offen offset:1024 sc1
    s_branch STD_25
RETRY_27:
    buffer_load_dword v16, v9, s[20:23], s60 offen offset:1024 sc1
    s_waitcnt vmcnt(0)
    s_sub_u32 s29, s29, 1
    s_cbranch_scc0 SPIN_26
    s_mov_b32 s29, 0
    s_branch DONE_28
L_CODE_END:
.section .rodata,"a"
.p2align 6
.amdhsa_kernel parallel_sum__sliding_local_dilated__mixer_s_mlp__prompt_kernel
  .amdhsa_next_free_vgpr 256
  .amdhsa_next_free_sgpr 102
  .amdhsa_accum_offset 256
  .amdhsa_group_segment_fixed_size 0
  .amdhsa_kernarg_size 88
  .amdhsa_user_sgpr_count 2
  .amdhsa_user_sgpr_kernarg_segment_ptr 1
  .amdhsa_system_sgpr_workgroup_id_x 1
.end_amdhsa_kernel
```
